```python
import torch

def _softmax(x, axis=-1):
    return torch.softmax(x, dim=axis)

def _gelu(x):
    return torch.nn.functional.gelu(x, approximate='tanh')

def _silu(x):
    return torch.nn.functional.silu(x)

def _sigmoid(x):
    return torch.sigmoid(x)

def _layernorm(x, axis=-1, eps=1e-05):
    m = x.mean(dim=axis, keepdim=True)
    v = x.var(dim=axis, keepdim=True, unbiased=False)
    return (x - m) / torch.sqrt(v + eps)

def _scatter_add(tgt, idx, src, axis=0):
    return tgt.clone().index_add_(axis, idx, src)

def _segment_sum(src, seg, n):
    out = torch.zeros((n,) + src.shape[1:], dtype=src.dtype)
    return out.index_add_(0, seg, src)

def _pad(x, pw):
    flat = tuple((v for pair in reversed(pw) for v in pair))
    return torch.nn.functional.pad(x, flat)
kernel_name = 'standalone__tree_speculative_verify_tree_attention_over_candidate_token_tree__decode'

def setup_inputs():

    _w = lambda a: (lambda t: t.to(torch.bfloat16) if t.is_floating_point() else t)(torch.as_tensor(a))
    B, Hq, Hkv, T, C, D = (1, 32, 16, 1, 65536, 128)
    tree_mask = torch.zeros((B, T, T), dtype=float)
    for b in range(B):
        parent = torch.zeros(T, dtype=torch.int64)
        for i in range(1, T):
            parent[i] = int(torch.randint(0, i, (1,)).item())
        for i in range(T):
            j = i
            tree_mask[b, i, j] = 1.0
            while j > 0:
                j = parent[j]
                tree_mask[b, i, j] = 1.0
    return {'q': _w((lambda *s: torch.randn(*s, dtype=torch.bfloat16) * 0.8)(B, Hq, T, D)), 'k_cache': _w((lambda *s: torch.randn(*s, dtype=torch.bfloat16) * 0.8)(B, Hkv, C, D)), 'v_cache': _w((lambda *s: torch.randn(*s, dtype=torch.bfloat16) * 0.05)(B, Hkv, C, D)), 'k_tree': _w((lambda *s: torch.randn(*s, dtype=torch.bfloat16) * 0.8)(B, Hkv, T, D)), 'v_tree': _w((lambda *s: torch.randn(*s, dtype=torch.bfloat16) * 0.05)(B, Hkv, T, D)), 'tree_mask': _w(tree_mask)}

def reference(q, k_cache, v_cache, k_tree, v_tree, tree_mask):
    B, Hq, T, D = q.shape
    Hkv, C = (k_cache.shape[1], k_cache.shape[2])
    rep = Hq // Hkv
    kc = (lambda x, n, axis: torch.repeat_interleave(x, n, dim=axis))(k_cache, rep, axis=1)
    vc = (lambda x, n, axis: torch.repeat_interleave(x, n, dim=axis))(v_cache, rep, axis=1)
    kt = (lambda x, n, axis: torch.repeat_interleave(x, n, dim=axis))(k_tree, rep, axis=1)
    vt = (lambda x, n, axis: torch.repeat_interleave(x, n, dim=axis))(v_tree, rep, axis=1)
    k = torch.concatenate([kc, kt], axis=2)
    v = torch.concatenate([vc, vt], axis=2)
    scale = D ** (-0.5)
    scores = torch.einsum('bhqd,bhkd->bhqk', q, k) * scale
    ctx_mask = torch.ones((B, 1, T, C), dtype=scores.dtype)
    tm = tree_mask[:, None, :, :].clone()
    full_mask = torch.concatenate([ctx_mask, tm], axis=-1)
    scores = scores + (1.0 - full_mask) * -1000000000.0
    p = _softmax(scores, axis=-1)
    return torch.einsum('bhqk,bhkd->bhqd', p, v)
```

```asm
; @launch grid=(257,1,1) block=(64,1,1) lds=32768
.amdgcn_target "amdgcn-amd-amdhsa--gfx950"
.text
.globl standalone__tree_speculative_verify_tree_attention_over_candidate_token_tree__decode_kernel
.p2align 8
.type standalone__tree_speculative_verify_tree_attention_over_candidate_token_tree__decode_kernel,@function
standalone__tree_speculative_verify_tree_attention_over_candidate_token_tree__decode_kernel:
    s_load_dwordx16 s[4:19], s[0:1], 0
    s_load_dwordx2 s[20:21], s[0:1], 64
    s_cmp_ge_u32 s2, 256
    s_cbranch_scc1 L_extra
    s_getpc_b64 s[60:61]
L_pc0:
    s_lshr_b32 s52, s2, 3
    s_mul_i32 s52, s52, 896
    v_lshl_add_u32 v4, v0, 7, s52
    v_min_u32 v4, L_code_end-L_pc0-4, v4
    v_mov_b32 v5, 0
    v_lshl_add_u64 v[4:5], v[4:5], 0, s[60:61]
    s_mov_b64 exec, 127
    global_load_dword v16, v[4:5], off
    s_mov_b64 exec, -1
    s_lshr_b32 s48, s2, 4
    s_and_b32 s63, s2, 7
    s_mov_b32 s52, 0x64315320
    s_mov_b32 s53, 0x97648653
    s_lshl_b32 s55, s48, 2
    s_lshr_b64 s[52:53], s[52:53], s55
    s_and_b32 s70, s52, 15
    s_mov_b32 s52, 0xa060400
    s_mov_b32 s53, 0x110d0b07
    s_lshl_b32 s55, s63, 3
    s_lshr_b64 s[52:53], s[52:53], s55
    s_and_b32 s52, s52, 0xff
    s_add_u32 s70, s70, s52
    s_andn2_b32 s52, s70, 7
    s_and_b32 s53, s2, 8
    s_lshl1_add_u32 s56, s52, s53
    s_lshl_b32 s56, s56, 12
    s_and_b32 s70, s70, 7
    s_lshl_b32 s70, s70, 12
    s_lshl3_add_u32 s57, s48, s63
    s_lshl_b32 s57, s57, 21
    s_mov_b32 s26, 0x200000
    s_mov_b32 s27, 0x20000
    v_and_b32 v6, 3, v0
    v_bfe_u32 v7, v0, 2, 2
    v_lshrrev_b32 v8, 4, v0
    v_lshlrev_b32 v1, 4, v6
    v_lshl_add_u32 v1, v7, 8, v1
    v_lshl_add_u32 v1, v8, 6, v1
    s_add_u32 s52, s70, 0x1000
    s_and_b32 s53, s52, 0x8000
    s_add_u32 s71, s52, s53
    s_add_u32 s52, s70, 0x2000
    s_and_b32 s53, s52, 0x8000
    s_add_u32 s72, s52, s53
    s_add_u32 s52, s70, 0x3000
    s_and_b32 s53, s52, 0x8000
    s_add_u32 s73, s52, s53
    s_add_u32 s52, s70, 0x4000
    s_and_b32 s53, s52, 0x8000
    s_add_u32 s74, s52, s53
    s_add_u32 s52, s70, 0x5000
    s_and_b32 s53, s52, 0x8000
    s_add_u32 s75, s52, s53
    s_add_u32 s52, s70, 0x6000
    s_and_b32 s53, s52, 0x8000
    s_add_u32 s76, s52, s53
    s_add_u32 s52, s70, 0x7000
    s_and_b32 s53, s52, 0x8000
    s_add_u32 s77, s52, s53
    v_and_b32 v6, 1, v0
    v_lshlrev_b32 v6, 8, v6
    v_lshl_add_u32 v6, v7, 4, v6
    v_lshl_add_u32 v6, v8, 6, v6
    v_lshlrev_b32 v2, 4, v0
    s_lshl_b32 s52, s48, 9
    s_lshl_b32 s53, s48, 8
    s_movk_i32 s38, 512
    s_mov_b32 s39, 0x20000
    s_movk_i32 s34, 256
    s_mov_b32 s35, 0x20000
    s_add_u32 s55, s56, s70
    s_and_b32 s55, s55, 0x1fffff
    s_waitcnt lgkmcnt(0)
    s_add_u32 s24, s6, s57
    s_addc_u32 s25, s7, 0
    buffer_load_dwordx4 v[68:71], v1, s[24:27], s55 offen offset:0 nt
    buffer_load_dwordx4 v[72:75], v1, s[24:27], s55 offen offset:1024 nt
    buffer_load_dwordx4 v[76:79], v1, s[24:27], s55 offen offset:2048 nt
    buffer_load_dwordx4 v[80:83], v1, s[24:27], s55 offen offset:3072 nt
    s_add_u32 s36, s4, s52
    s_addc_u32 s37, s5, 0
    buffer_load_dwordx4 v[36:39], v6, s[36:39], 0 offen
    s_add_u32 s32, s10, s53
    s_addc_u32 s33, s11, 0
    buffer_load_dwordx4 v[64:67], v1, s[32:35], 0 offen
    s_add_u32 s32, s12, s53
    s_addc_u32 s33, s13, 0
    buffer_load_dwordx4 v[60:63], v2, s[32:35], 0 offen
    s_mov_b64 s[36:37], s[14:15]
    s_mov_b32 s38, 2
    buffer_load_ushort v13, off, s[36:39], 0
    s_add_u32 s55, s56, s71
    s_and_b32 s55, s55, 0x1fffff
    buffer_load_dwordx4 v[84:87], v1, s[24:27], s55 offen offset:0 nt
    buffer_load_dwordx4 v[88:91], v1, s[24:27], s55 offen offset:1024 nt
    buffer_load_dwordx4 v[92:95], v1, s[24:27], s55 offen offset:2048 nt
    buffer_load_dwordx4 v[96:99], v1, s[24:27], s55 offen offset:3072 nt
    s_add_u32 s55, s56, s72
    s_and_b32 s55, s55, 0x1fffff
    buffer_load_dwordx4 v[100:103], v1, s[24:27], s55 offen offset:0 nt
    buffer_load_dwordx4 v[104:107], v1, s[24:27], s55 offen offset:1024 nt
    buffer_load_dwordx4 v[108:111], v1, s[24:27], s55 offen offset:2048 nt
    buffer_load_dwordx4 v[112:115], v1, s[24:27], s55 offen offset:3072 nt
    s_add_u32 s55, s56, s73
    s_and_b32 s55, s55, 0x1fffff
    buffer_load_dwordx4 v[116:119], v1, s[24:27], s55 offen offset:0 nt
    buffer_load_dwordx4 v[120:123], v1, s[24:27], s55 offen offset:1024 nt
    buffer_load_dwordx4 v[124:127], v1, s[24:27], s55 offen offset:2048 nt
    buffer_load_dwordx4 v[128:131], v1, s[24:27], s55 offen offset:3072 nt
    s_add_u32 s55, s56, s74
    s_and_b32 s55, s55, 0x1fffff
    buffer_load_dwordx4 v[132:135], v1, s[24:27], s55 offen offset:0 nt
    buffer_load_dwordx4 v[136:139], v1, s[24:27], s55 offen offset:1024 nt
    buffer_load_dwordx4 v[140:143], v1, s[24:27], s55 offen offset:2048 nt
    buffer_load_dwordx4 v[144:147], v1, s[24:27], s55 offen offset:3072 nt
    s_add_u32 s55, s56, s75
    s_and_b32 s55, s55, 0x1fffff
    buffer_load_dwordx4 v[148:151], v1, s[24:27], s55 offen offset:0 nt
    buffer_load_dwordx4 v[152:155], v1, s[24:27], s55 offen offset:1024 nt
    buffer_load_dwordx4 v[156:159], v1, s[24:27], s55 offen offset:2048 nt
    buffer_load_dwordx4 v[160:163], v1, s[24:27], s55 offen offset:3072 nt
    s_add_u32 s55, s56, s76
    s_and_b32 s55, s55, 0x1fffff
    buffer_load_dwordx4 v[164:167], v1, s[24:27], s55 offen offset:0 nt
    buffer_load_dwordx4 v[168:171], v1, s[24:27], s55 offen offset:1024 nt
    s_and_b32 s49, s2, 15
    s_mul_i32 s68, s48, 20736
    s_add_u32 s28, s20, s68
    s_addc_u32 s29, s21, 0
    s_mov_b32 s30, 20736
    s_mov_b32 s31, 0x20000
    s_mul_i32 s68, s49, 1152
    v_mov_b32 v28, -1
    v_mov_b32 v29, -1
    v_mov_b32 v30, -1
    v_mov_b32 v31, -1
    buffer_store_dwordx4 v[28:31], v2, s[28:31], s68 offen sc1
    s_mov_b64 exec, 0xff
    buffer_store_dwordx4 v[28:31], v2, s[28:31], s68 offen offset:1024 sc1
    s_mov_b64 exec, -1
    s_add_u32 s58, s8, s57
    s_addc_u32 s59, s9, 0
    s_mov_b32 s54, s56
    s_mov_b32 s50, 0x3e0293ee
    s_mov_b32 s51, 0
    s_mov_b64 s[32:33], s[18:19]
    s_mov_b32 s34, 4
    s_add_u32 s44, s20, 995328
    s_addc_u32 s45, s21, 0
    s_movk_i32 s46, 256
    s_mov_b32 s47, 0x20000
    v_lshlrev_b32 v17, 2, v0
    v_mov_b32 v18, 0
    buffer_store_dword v18, v17, s[44:47], 0 offen
    s_and_b32 s53, s2, 8
    s_lshl_b32 s53, s53, 4
    s_lshl1_add_u32 s52, s48, s53
    s_add_u32 s40, s44, s52
    s_addc_u32 s41, s45, 0
    s_xor_b32 s53, s53, 128
    s_add_u32 s36, s44, s53
    s_addc_u32 s37, s45, 0
    s_movk_i32 s38, 48
    s_add_u32 s63, s63, 16
    s_lshl1_add_u32 s44, s63, s44
    s_addc_u32 s45, s45, 0
    s_movk_i32 s46, 130
    s_mov_b32 s42, 2
    s_lshr_b32 s52, s2, 3
    s_mov_b32 s43, 0x20000
    s_mov_b32 s47, 0x20000
    s_mul_i32 s64, s52, 13
    s_and_b32 s64, s64, 31
    s_mul_i32 s65, s64, 20736
    s_add_u32 s65, s65, 350208
    s_mul_i32 s64, s64, 4
    s_add_u32 s64, s64, 7
    s_cmp_ge_u32 s64, 59
    s_cselect_b32 s64, 0x7fff, s64
    v_lshlrev_b32 v17, 1, v0
    v_mov_b32 v18, 0
    v_mov_b32 v19, 0
    v_mov_b32 v3, v2
    v_bfe_u32 v6, v0, 3, 1
    v_mul_u32_u24 v6, 0x0202, v6
    v_add_u32 v6, 0x0100, v6
    v_xor_b32 v6, 0x0c0c, v6
    v_and_b32 v7, 1, v0
    v_lshlrev_b32 v7, 4, v7
    v_lshlrev_b32 v6, v7, v6
    v_xor_b32 v6, 0x0c0c0c0c, v6
    v_bfe_u32 v7, v0, 1, 2
    v_mov_b32 v8, 0x0c0c0c0c
    v_cmp_eq_u32 vcc, 0, v7
    s_nop 1
    v_cndmask_b32 v32, v8, v6, vcc
    v_cmp_eq_u32 vcc, 1, v7
    s_nop 1
    v_cndmask_b32 v33, v8, v6, vcc
    v_cmp_eq_u32 vcc, 2, v7
    s_nop 1
    v_cndmask_b32 v34, v8, v6, vcc
    v_cmp_eq_u32 vcc, 3, v7
    s_nop 1
    v_cndmask_b32 v35, v8, v6, vcc
    v_and_b32 v6, 2, v0
    v_cmp_eq_u32 vcc, 0, v6
    s_nop 0
    s_waitcnt vmcnt(22)
    v_cndmask_b32 v40, v36, 0, vcc
    v_cndmask_b32 v41, v37, 0, vcc
    v_cndmask_b32 v42, v38, 0, vcc
    v_cndmask_b32 v43, v39, 0, vcc
    v_cndmask_b32 v36, 0, v36, vcc
    v_cndmask_b32 v37, 0, v37, vcc
    v_cndmask_b32 v38, 0, v38, vcc
    v_cndmask_b32 v39, 0, v39, vcc
    v_lshlrev_b32 v13, 16, v13
    v_sub_f32 v13, 1.0, v13
    v_mfma_f32_16x16x32_bf16 v[44:47], v[64:67], v[36:39], 0
    v_mul_f32 v13, 0xd028965f, v13
    s_cmp_eq_u32 s49, 0
    s_cselect_b64 vcc, 3, 0
    v_mov_b32 v10, 0xff800000
    s_nop 4
    v_add_f32 v13, v13, v44
    v_mov_b32_dpp v6, v45 row_ror:12 row_mask:0xf bank_mask:0xf
    v_mov_b32_dpp v7, v46 row_ror:8 row_mask:0xf bank_mask:0xf
    v_mov_b32_dpp v8, v47 row_ror:4 row_mask:0xf bank_mask:0xf
    v_add_f32 v13, v13, v6
    v_add_f32 v7, v7, v8
    v_add_f32 v13, v13, v7
    v_cndmask_b32 v13, v10, v13, vcc
    v_mov_b32 v10, v13
.p2align 3
L_k2:
    v_mfma_f32_16x16x32_bf16 v[44:47], v[68:71], v[36:39], 0
    s_waitcnt vmcnt(21)
    buffer_load_dwordx4 v[172:175], v1, s[24:27], s55 offen offset:2048 nt
    s_nop 1
    v_mfma_f32_16x16x32_bf16 v[44:47], v[72:75], v[40:43], v[44:47]
    s_waitcnt vmcnt(21)
    buffer_load_dwordx4 v[176:179], v1, s[24:27], s55 offen offset:3072 nt
    s_nop 1
    v_mfma_f32_16x16x32_bf16 v[48:51], v[76:79], v[36:39], 0
    s_add_u32 s55, s54, s77
    s_and_b32 s55, s55, 0x1fffff
    s_waitcnt vmcnt(21)
    buffer_load_dwordx4 v[180:183], v1, s[24:27], s55 offen offset:0 nt
    s_nop 1
    v_mfma_f32_16x16x32_bf16 v[48:51], v[80:83], v[40:43], v[48:51]
    s_waitcnt vmcnt(21)
    buffer_load_dwordx4 v[184:187], v1, s[24:27], s55 offen offset:1024 nt
    v_mov_b32_dpp v11, v44 quad_perm:[0,1,2,3] row_mask:0xf bank_mask:0x1
    v_mov_b32_dpp v12, v45 row_ror:12 row_mask:0xf bank_mask:0x1
    v_mfma_f32_16x16x32_bf16 v[52:55], v[84:87], v[36:39], 0
    s_waitcnt vmcnt(21)
    buffer_load_dwordx4 v[188:191], v1, s[24:27], s55 offen offset:2048 nt
    v_add_f32_dpp v11, v46, v11 row_ror:8 row_mask:0xf bank_mask:0x1
    v_add_f32_dpp v12, v47, v12 row_ror:4 row_mask:0xf bank_mask:0x1
    v_mfma_f32_16x16x32_bf16 v[52:55], v[88:91], v[40:43], v[52:55]
    s_waitcnt vmcnt(21)
    buffer_load_dwordx4 v[192:195], v1, s[24:27], s55 offen offset:3072 nt
    v_mov_b32_dpp v11, v48 row_ror:4 row_mask:0xf bank_mask:0x2
    v_mov_b32_dpp v12, v49 quad_perm:[0,1,2,3] row_mask:0xf bank_mask:0x2
    v_mfma_f32_16x16x32_bf16 v[56:59], v[92:95], v[36:39], 0
    s_add_u32 s54, s54, 0x10000
    s_cmp_lg_u32 s51, 31
    s_cbranch_scc1 L_k2_same
    s_mov_b64 s[24:25], s[58:59]
    v_mov_b32 v1, v2
L_k2_same:
    s_add_u32 s55, s54, s70
    s_and_b32 s55, s55, 0x1fffff
    s_waitcnt vmcnt(21)
    buffer_load_dwordx4 v[68:71], v1, s[24:27], s55 offen offset:0 nt
    v_add_f32_dpp v11, v50, v11 row_ror:12 row_mask:0xf bank_mask:0x2
    v_add_f32_dpp v12, v51, v12 row_ror:8 row_mask:0xf bank_mask:0x2
    v_mfma_f32_16x16x32_bf16 v[56:59], v[96:99], v[40:43], v[56:59]
    s_waitcnt vmcnt(21)
    buffer_load_dwordx4 v[72:75], v1, s[24:27], s55 offen offset:1024 nt
    v_mov_b32_dpp v11, v52 row_ror:8 row_mask:0xf bank_mask:0x4
    v_mov_b32_dpp v12, v53 row_ror:4 row_mask:0xf bank_mask:0x4
    v_mfma_f32_16x16x32_bf16 v[44:47], v[100:103], v[36:39], 0
    s_waitcnt vmcnt(21)
    buffer_load_dwordx4 v[76:79], v1, s[24:27], s55 offen offset:2048 nt
    v_add_f32_dpp v11, v54, v11 quad_perm:[0,1,2,3] row_mask:0xf bank_mask:0x4
    v_add_f32_dpp v12, v55, v12 row_ror:12 row_mask:0xf bank_mask:0x4
    v_add_u32 v18, 1, v18
    buffer_store_short v18, v17, s[40:43], 0 offen
    v_mfma_f32_16x16x32_bf16 v[44:47], v[104:107], v[40:43], v[44:47]
    s_waitcnt vmcnt(21)
    buffer_load_dwordx4 v[80:83], v1, s[24:27], s55 offen offset:3072 nt
    v_mov_b32_dpp v11, v56 row_ror:12 row_mask:0xf bank_mask:0x8
    v_mov_b32_dpp v12, v57 row_ror:8 row_mask:0xf bank_mask:0x8
    v_mfma_f32_16x16x32_bf16 v[48:51], v[108:111], v[36:39], 0
    s_add_u32 s55, s54, s71
    s_and_b32 s55, s55, 0x1fffff
    s_waitcnt vmcnt(21)
    buffer_load_dwordx4 v[84:87], v1, s[24:27], s55 offen offset:0 nt
    v_add_f32_dpp v11, v58, v11 row_ror:4 row_mask:0xf bank_mask:0x8
    v_add_f32_dpp v12, v59, v12 quad_perm:[0,1,2,3] row_mask:0xf bank_mask:0x8
    v_add_f32 v24, v11, v12
    v_mfma_f32_16x16x32_bf16 v[48:51], v[112:115], v[40:43], v[48:51]
    s_waitcnt vmcnt(21)
    buffer_load_dwordx4 v[88:91], v1, s[24:27], s55 offen offset:1024 nt
    v_mov_b32_dpp v11, v44 quad_perm:[0,1,2,3] row_mask:0xf bank_mask:0x1
    v_mov_b32_dpp v12, v45 row_ror:12 row_mask:0xf bank_mask:0x1
    s_lshl1_add_u32 s52, s51, -1
    s_max_i32 s52, s52, 0
    v_cmp_lt_u32 vcc, s52, v19
    s_and_b32 s60, vcc_lo, 0xffff
    s_bcnt1_i32_b32 s60, s60
    v_cmp_gt_u32 vcc, s52, v19
    s_and_b32 s61, vcc_lo, 0xffff
    s_bcnt1_i32_b32 s61, s61
    v_readlane_b32 s62, v19, s63
    v_mfma_f32_16x16x32_bf16 v[52:55], v[116:119], v[36:39], 0
    s_waitcnt vmcnt(21)
    buffer_load_dwordx4 v[92:95], v1, s[24:27], s55 offen offset:2048 nt
    v_add_f32_dpp v11, v46, v11 row_ror:8 row_mask:0xf bank_mask:0x1
    v_add_f32_dpp v12, v47, v12 row_ror:4 row_mask:0xf bank_mask:0x1
    v_mfma_f32_16x16x32_bf16 v[52:55], v[120:123], v[40:43], v[52:55]
    s_waitcnt vmcnt(21)
    buffer_load_dwordx4 v[96:99], v1, s[24:27], s55 offen offset:3072 nt
    v_mov_b32_dpp v11, v48 row_ror:4 row_mask:0xf bank_mask:0x2
    v_mov_b32_dpp v12, v49 quad_perm:[0,1,2,3] row_mask:0xf bank_mask:0x2
    s_sext_i32_i16 s53, s62
    s_sub_i32 s60, s60, s61
    s_add_i32 s60, s60, s53
    s_cmp_gt_i32 s60, -4
    s_cselect_b32 s67, 1, 0
    s_cmp_gt_i32 s60, -1
    s_cselect_b32 s67, 2, s67
    s_cmp_gt_i32 s60, 2
    s_cselect_b32 s67, 3, s67
    s_cmp_gt_i32 s60, 5
    s_cselect_b32 s67, 4, s67
    v_mfma_f32_16x16x32_bf16 v[56:59], v[124:127], v[36:39], 0
    s_add_u32 s55, s54, s72
    s_and_b32 s55, s55, 0x1fffff
    s_waitcnt vmcnt(21)
    buffer_load_dwordx4 v[100:103], v1, s[24:27], s55 offen offset:0 nt
    v_add_f32_dpp v11, v50, v11 row_ror:12 row_mask:0xf bank_mask:0x2
    v_add_f32_dpp v12, v51, v12 row_ror:8 row_mask:0xf bank_mask:0x2
    s_cmp_lg_u32 s67, 2
    s_cbranch_scc1 L_k_pick
L_k2_u:
    v_mfma_f32_16x16x32_bf16 v[56:59], v[128:131], v[40:43], v[56:59]
    s_waitcnt vmcnt(21)
    buffer_load_dwordx4 v[104:107], v1, s[24:27], s55 offen offset:1024 nt
    v_mov_b32_dpp v11, v52 row_ror:8 row_mask:0xf bank_mask:0x4
    v_mov_b32_dpp v12, v53 row_ror:4 row_mask:0xf bank_mask:0x4
    v_mfma_f32_16x16x32_bf16 v[44:47], v[132:135], v[36:39], 0
    s_waitcnt vmcnt(21)
    buffer_load_dwordx4 v[108:111], v1, s[24:27], s55 offen offset:2048 nt
    v_add_f32_dpp v11, v54, v11 quad_perm:[0,1,2,3] row_mask:0xf bank_mask:0x4
    v_add_f32_dpp v12, v55, v12 row_ror:12 row_mask:0xf bank_mask:0x4
    buffer_load_ushort v19, v17, s[36:39], 0 offen sc1
    v_mfma_f32_16x16x32_bf16 v[44:47], v[136:139], v[40:43], v[44:47]
    s_waitcnt vmcnt(21)
    buffer_load_dwordx4 v[112:115], v1, s[24:27], s55 offen offset:3072 nt
    v_mov_b32_dpp v11, v56 row_ror:12 row_mask:0xf bank_mask:0x8
    v_mov_b32_dpp v12, v57 row_ror:8 row_mask:0xf bank_mask:0x8
    v_mfma_f32_16x16x32_bf16 v[48:51], v[140:143], v[36:39], 0
    s_add_u32 s55, s54, s73
    s_and_b32 s55, s55, 0x1fffff
    s_waitcnt vmcnt(21)
    buffer_load_dwordx4 v[116:119], v1, s[24:27], s55 offen offset:0 nt
    v_add_f32_dpp v11, v58, v11 row_ror:4 row_mask:0xf bank_mask:0x8
    v_add_f32_dpp v12, v59, v12 quad_perm:[0,1,2,3] row_mask:0xf bank_mask:0x8
    v_add_f32 v25, v11, v12
    v_mfma_f32_16x16x32_bf16 v[48:51], v[144:147], v[40:43], v[48:51]
    s_waitcnt vmcnt(21)
    buffer_load_dwordx4 v[120:123], v1, s[24:27], s55 offen offset:1024 nt
    v_mov_b32_dpp v11, v44 quad_perm:[0,1,2,3] row_mask:0xf bank_mask:0x1
    v_mov_b32_dpp v12, v45 row_ror:12 row_mask:0xf bank_mask:0x1
    v_mfma_f32_16x16x32_bf16 v[52:55], v[148:151], v[36:39], 0
    s_waitcnt vmcnt(21)
    buffer_load_dwordx4 v[124:127], v1, s[24:27], s55 offen offset:2048 nt
    v_add_f32_dpp v11, v46, v11 row_ror:8 row_mask:0xf bank_mask:0x1
    v_add_f32_dpp v12, v47, v12 row_ror:4 row_mask:0xf bank_mask:0x1
    v_mfma_f32_16x16x32_bf16 v[52:55], v[152:155], v[40:43], v[52:55]
    s_waitcnt vmcnt(21)
    buffer_load_dwordx4 v[128:131], v1, s[24:27], s55 offen offset:3072 nt
    v_mov_b32_dpp v11, v48 row_ror:4 row_mask:0xf bank_mask:0x2
    v_mov_b32_dpp v12, v49 quad_perm:[0,1,2,3] row_mask:0xf bank_mask:0x2
    v_mfma_f32_16x16x32_bf16 v[56:59], v[156:159], v[36:39], 0
    s_add_u32 s55, s54, s74
    s_and_b32 s55, s55, 0x1fffff
    s_waitcnt vmcnt(21)
    buffer_load_dwordx4 v[132:135], v1, s[24:27], s55 offen offset:0 nt
    v_add_f32_dpp v11, v50, v11 row_ror:12 row_mask:0xf bank_mask:0x2
    v_add_f32_dpp v12, v51, v12 row_ror:8 row_mask:0xf bank_mask:0x2
    v_add_u32 v18, 1, v18
    buffer_store_short v18, v17, s[40:43], 0 offen
    v_mfma_f32_16x16x32_bf16 v[56:59], v[160:163], v[40:43], v[56:59]
    s_waitcnt vmcnt(21)
    buffer_load_dwordx4 v[136:139], v1, s[24:27], s55 offen offset:1024 nt
    v_mov_b32_dpp v11, v52 row_ror:8 row_mask:0xf bank_mask:0x4
    v_mov_b32_dpp v12, v53 row_ror:4 row_mask:0xf bank_mask:0x4
    v_mfma_f32_16x16x32_bf16 v[44:47], v[164:167], v[36:39], 0
    s_waitcnt vmcnt(21)
    buffer_load_dwordx4 v[140:143], v1, s[24:27], s55 offen offset:2048 nt
    v_add_f32_dpp v11, v54, v11 quad_perm:[0,1,2,3] row_mask:0xf bank_mask:0x4
    v_add_f32_dpp v12, v55, v12 row_ror:12 row_mask:0xf bank_mask:0x4
    v_mfma_f32_16x16x32_bf16 v[44:47], v[168:171], v[40:43], v[44:47]
    s_waitcnt vmcnt(21)
    buffer_load_dwordx4 v[144:147], v1, s[24:27], s55 offen offset:3072 nt
    v_mov_b32_dpp v11, v56 row_ror:12 row_mask:0xf bank_mask:0x8
    v_mov_b32_dpp v12, v57 row_ror:8 row_mask:0xf bank_mask:0x8
    s_sub_u32 s52, s51, s64
    s_cmp_lt_u32 s52, 3
    s_cbranch_scc1 L_k2_round
L_k2_t:
    v_mfma_f32_16x16x32_bf16 v[48:51], v[172:175], v[36:39], 0
    s_add_u32 s55, s54, s75
    s_and_b32 s55, s55, 0x1fffff
    s_waitcnt vmcnt(21)
    buffer_load_dwordx4 v[148:151], v1, s[24:27], s55 offen offset:0 nt
    v_add_f32_dpp v11, v58, v11 row_ror:4 row_mask:0xf bank_mask:0x8
    v_add_f32_dpp v12, v59, v12 quad_perm:[0,1,2,3] row_mask:0xf bank_mask:0x8
    v_add_f32 v26, v11, v12
    v_mfma_f32_16x16x32_bf16 v[48:51], v[176:179], v[40:43], v[48:51]
    s_waitcnt vmcnt(21)
    buffer_load_dwordx4 v[152:155], v1, s[24:27], s55 offen offset:1024 nt
    v_mov_b32_dpp v11, v44 quad_perm:[0,1,2,3] row_mask:0xf bank_mask:0x1
    v_mov_b32_dpp v12, v45 row_ror:12 row_mask:0xf bank_mask:0x1
    v_mfma_f32_16x16x32_bf16 v[52:55], v[180:183], v[36:39], 0
    s_waitcnt vmcnt(21)
    buffer_load_dwordx4 v[156:159], v1, s[24:27], s55 offen offset:2048 nt
    v_add_f32_dpp v11, v46, v11 row_ror:8 row_mask:0xf bank_mask:0x1
    v_add_f32_dpp v12, v47, v12 row_ror:4 row_mask:0xf bank_mask:0x1
    v_mfma_f32_16x16x32_bf16 v[52:55], v[184:187], v[40:43], v[52:55]
    s_waitcnt vmcnt(21)
    buffer_load_dwordx4 v[160:163], v1, s[24:27], s55 offen offset:3072 nt
    v_mov_b32_dpp v11, v48 row_ror:4 row_mask:0xf bank_mask:0x2
    v_mov_b32_dpp v12, v49 quad_perm:[0,1,2,3] row_mask:0xf bank_mask:0x2
    v_mfma_f32_16x16x32_bf16 v[56:59], v[188:191], v[36:39], 0
    s_add_u32 s55, s54, s76
    s_and_b32 s55, s55, 0x1fffff
    s_waitcnt vmcnt(21)
    buffer_load_dwordx4 v[164:167], v1, s[24:27], s55 offen offset:0 nt
    v_add_f32_dpp v11, v50, v11 row_ror:12 row_mask:0xf bank_mask:0x2
    v_add_f32_dpp v12, v51, v12 row_ror:8 row_mask:0xf bank_mask:0x2
    v_mfma_f32_16x16x32_bf16 v[56:59], v[192:195], v[40:43], v[56:59]
    s_waitcnt vmcnt(21)
    buffer_load_dwordx4 v[168:171], v1, s[24:27], s55 offen offset:1024 nt
    v_mov_b32_dpp v11, v52 row_ror:8 row_mask:0xf bank_mask:0x4
    v_mov_b32_dpp v12, v53 row_ror:4 row_mask:0xf bank_mask:0x4
    s_add_u32 s51, s51, 1
    s_nop 0
    v_add_f32_dpp v11, v54, v11 quad_perm:[0,1,2,3] row_mask:0xf bank_mask:0x4
    v_add_f32_dpp v12, v55, v12 row_ror:12 row_mask:0xf bank_mask:0x4
    s_nop 1
    v_mov_b32_dpp v11, v56 row_ror:12 row_mask:0xf bank_mask:0x8
    v_mov_b32_dpp v12, v57 row_ror:8 row_mask:0xf bank_mask:0x8
    s_cmp_lg_u32 s51, 32
    v_add_f32_dpp v11, v58, v11 row_ror:4 row_mask:0xf bank_mask:0x8
    v_add_f32_dpp v12, v59, v12 quad_perm:[0,1,2,3] row_mask:0xf bank_mask:0x8
    v_add_f32 v27, v11, v12
    v_max3_f32 v10, v10, v24, v25
    v_max3_f32 v10, v10, v26, v27
    ds_write_b128 v3, v[24:27]
    v_add_u32 v3, 1024, v3
    s_cbranch_scc1 L_k2
    s_branch L_mid
.p2align 6
L_k0:
    v_mfma_f32_16x16x32_bf16 v[44:47], v[68:71], v[36:39], 0
    s_waitcnt vmcnt(19)
    buffer_load_dwordx4 v[172:175], v1, s[24:27], s55 offen offset:2048 nt
    s_nop 1
    v_mfma_f32_16x16x32_bf16 v[44:47], v[72:75], v[40:43], v[44:47]
    s_waitcnt vmcnt(19)
    buffer_load_dwordx4 v[176:179], v1, s[24:27], s55 offen offset:3072 nt
    s_nop 1
    v_mfma_f32_16x16x32_bf16 v[48:51], v[76:79], v[36:39], 0
    s_add_u32 s55, s54, s77
    s_and_b32 s55, s55, 0x1fffff
    s_waitcnt vmcnt(19)
    buffer_load_dwordx4 v[180:183], v1, s[24:27], s55 offen offset:0 nt
    s_nop 1
    v_mfma_f32_16x16x32_bf16 v[48:51], v[80:83], v[40:43], v[48:51]
    s_waitcnt vmcnt(19)
    buffer_load_dwordx4 v[184:187], v1, s[24:27], s55 offen offset:1024 nt
    v_mov_b32_dpp v11, v44 quad_perm:[0,1,2,3] row_mask:0xf bank_mask:0x1
    v_mov_b32_dpp v12, v45 row_ror:12 row_mask:0xf bank_mask:0x1
    v_mfma_f32_16x16x32_bf16 v[52:55], v[84:87], v[36:39], 0
    s_waitcnt vmcnt(19)
    buffer_load_dwordx4 v[188:191], v1, s[24:27], s55 offen offset:2048 nt
    v_add_f32_dpp v11, v46, v11 row_ror:8 row_mask:0xf bank_mask:0x1
    v_add_f32_dpp v12, v47, v12 row_ror:4 row_mask:0xf bank_mask:0x1
    v_mfma_f32_16x16x32_bf16 v[52:55], v[88:91], v[40:43], v[52:55]
    s_waitcnt vmcnt(19)
    buffer_load_dwordx4 v[192:195], v1, s[24:27], s55 offen offset:3072 nt
    v_mov_b32_dpp v11, v48 row_ror:4 row_mask:0xf bank_mask:0x2
    v_mov_b32_dpp v12, v49 quad_perm:[0,1,2,3] row_mask:0xf bank_mask:0x2
    v_mfma_f32_16x16x32_bf16 v[56:59], v[92:95], v[36:39], 0
    s_add_u32 s54, s54, 0x10000
    s_cmp_lg_u32 s51, 31
    s_cbranch_scc1 L_k0_same
    s_mov_b64 s[24:25], s[58:59]
    v_mov_b32 v1, v2
L_k0_same:
    s_add_u32 s55, s54, s70
    s_and_b32 s55, s55, 0x1fffff
    s_waitcnt vmcnt(19)
    buffer_load_dwordx4 v[68:71], v1, s[24:27], s55 offen offset:0 nt
    v_add_f32_dpp v11, v50, v11 row_ror:12 row_mask:0xf bank_mask:0x2
    v_add_f32_dpp v12, v51, v12 row_ror:8 row_mask:0xf bank_mask:0x2
    v_mfma_f32_16x16x32_bf16 v[56:59], v[96:99], v[40:43], v[56:59]
    s_waitcnt vmcnt(19)
    buffer_load_dwordx4 v[72:75], v1, s[24:27], s55 offen offset:1024 nt
    v_mov_b32_dpp v11, v52 row_ror:8 row_mask:0xf bank_mask:0x4
    v_mov_b32_dpp v12, v53 row_ror:4 row_mask:0xf bank_mask:0x4
    v_mfma_f32_16x16x32_bf16 v[44:47], v[100:103], v[36:39], 0
    s_waitcnt vmcnt(19)
    buffer_load_dwordx4 v[76:79], v1, s[24:27], s55 offen offset:2048 nt
    v_add_f32_dpp v11, v54, v11 quad_perm:[0,1,2,3] row_mask:0xf bank_mask:0x4
    v_add_f32_dpp v12, v55, v12 row_ror:12 row_mask:0xf bank_mask:0x4
    v_add_u32 v18, 1, v18
    buffer_store_short v18, v17, s[40:43], 0 offen
    v_mfma_f32_16x16x32_bf16 v[44:47], v[104:107], v[40:43], v[44:47]
    s_waitcnt vmcnt(19)
    buffer_load_dwordx4 v[80:83], v1, s[24:27], s55 offen offset:3072 nt
    v_mov_b32_dpp v11, v56 row_ror:12 row_mask:0xf bank_mask:0x8
    v_mov_b32_dpp v12, v57 row_ror:8 row_mask:0xf bank_mask:0x8
    v_mfma_f32_16x16x32_bf16 v[48:51], v[108:111], v[36:39], 0
    s_add_u32 s55, s54, s71
    s_and_b32 s55, s55, 0x1fffff
    s_waitcnt vmcnt(19)
    buffer_load_dwordx4 v[84:87], v1, s[24:27], s55 offen offset:0 nt
    v_add_f32_dpp v11, v58, v11 row_ror:4 row_mask:0xf bank_mask:0x8
    v_add_f32_dpp v12, v59, v12 quad_perm:[0,1,2,3] row_mask:0xf bank_mask:0x8
    v_add_f32 v24, v11, v12
    v_mfma_f32_16x16x32_bf16 v[48:51], v[112:115], v[40:43], v[48:51]
    s_waitcnt vmcnt(19)
    buffer_load_dwordx4 v[88:91], v1, s[24:27], s55 offen offset:1024 nt
    v_mov_b32_dpp v11, v44 quad_perm:[0,1,2,3] row_mask:0xf bank_mask:0x1
    v_mov_b32_dpp v12, v45 row_ror:12 row_mask:0xf bank_mask:0x1
    s_lshl1_add_u32 s52, s51, -1
    s_max_i32 s52, s52, 0
    v_cmp_lt_u32 vcc, s52, v19
    s_and_b32 s60, vcc_lo, 0xffff
    s_bcnt1_i32_b32 s60, s60
    v_cmp_gt_u32 vcc, s52, v19
    s_and_b32 s61, vcc_lo, 0xffff
    s_bcnt1_i32_b32 s61, s61
    v_readlane_b32 s62, v19, s63
    v_mfma_f32_16x16x32_bf16 v[52:55], v[116:119], v[36:39], 0
    s_waitcnt vmcnt(19)
    buffer_load_dwordx4 v[92:95], v1, s[24:27], s55 offen offset:2048 nt
    v_add_f32_dpp v11, v46, v11 row_ror:8 row_mask:0xf bank_mask:0x1
    v_add_f32_dpp v12, v47, v12 row_ror:4 row_mask:0xf bank_mask:0x1
    v_mfma_f32_16x16x32_bf16 v[52:55], v[120:123], v[40:43], v[52:55]
    s_waitcnt vmcnt(19)
    buffer_load_dwordx4 v[96:99], v1, s[24:27], s55 offen offset:3072 nt
    v_mov_b32_dpp v11, v48 row_ror:4 row_mask:0xf bank_mask:0x2
    v_mov_b32_dpp v12, v49 quad_perm:[0,1,2,3] row_mask:0xf bank_mask:0x2
    s_sext_i32_i16 s53, s62
    s_sub_i32 s60, s60, s61
    s_add_i32 s60, s60, s53
    s_cmp_gt_i32 s60, -4
    s_cselect_b32 s67, 1, 0
    s_cmp_gt_i32 s60, -1
    s_cselect_b32 s67, 2, s67
    s_cmp_gt_i32 s60, 2
    s_cselect_b32 s67, 3, s67
    s_cmp_gt_i32 s60, 5
    s_cselect_b32 s67, 4, s67
    v_mfma_f32_16x16x32_bf16 v[56:59], v[124:127], v[36:39], 0
    s_add_u32 s55, s54, s72
    s_and_b32 s55, s55, 0x1fffff
    s_waitcnt vmcnt(19)
    buffer_load_dwordx4 v[100:103], v1, s[24:27], s55 offen offset:0 nt
    v_add_f32_dpp v11, v50, v11 row_ror:12 row_mask:0xf bank_mask:0x2
    v_add_f32_dpp v12, v51, v12 row_ror:8 row_mask:0xf bank_mask:0x2
    s_cmp_lg_u32 s67, 0
    s_cbranch_scc1 L_k_pick
L_k0_u:
    v_mfma_f32_16x16x32_bf16 v[56:59], v[128:131], v[40:43], v[56:59]
    s_waitcnt vmcnt(19)
    buffer_load_dwordx4 v[104:107], v1, s[24:27], s55 offen offset:1024 nt
    v_mov_b32_dpp v11, v52 row_ror:8 row_mask:0xf bank_mask:0x4
    v_mov_b32_dpp v12, v53 row_ror:4 row_mask:0xf bank_mask:0x4
    v_mfma_f32_16x16x32_bf16 v[44:47], v[132:135], v[36:39], 0
    s_waitcnt vmcnt(19)
    buffer_load_dwordx4 v[108:111], v1, s[24:27], s55 offen offset:2048 nt
    v_add_f32_dpp v11, v54, v11 quad_perm:[0,1,2,3] row_mask:0xf bank_mask:0x4
    v_add_f32_dpp v12, v55, v12 row_ror:12 row_mask:0xf bank_mask:0x4
    buffer_load_ushort v19, v17, s[36:39], 0 offen sc1
    v_mfma_f32_16x16x32_bf16 v[44:47], v[136:139], v[40:43], v[44:47]
    s_waitcnt vmcnt(19)
    buffer_load_dwordx4 v[112:115], v1, s[24:27], s55 offen offset:3072 nt
    v_mov_b32_dpp v11, v56 row_ror:12 row_mask:0xf bank_mask:0x8
    v_mov_b32_dpp v12, v57 row_ror:8 row_mask:0xf bank_mask:0x8
    v_mfma_f32_16x16x32_bf16 v[48:51], v[140:143], v[36:39], 0
    s_add_u32 s55, s54, s73
    s_and_b32 s55, s55, 0x1fffff
    s_waitcnt vmcnt(19)
    buffer_load_dwordx4 v[116:119], v1, s[24:27], s55 offen offset:0 nt
    v_add_f32_dpp v11, v58, v11 row_ror:4 row_mask:0xf bank_mask:0x8
    v_add_f32_dpp v12, v59, v12 quad_perm:[0,1,2,3] row_mask:0xf bank_mask:0x8
    v_add_f32 v25, v11, v12
    v_mfma_f32_16x16x32_bf16 v[48:51], v[144:147], v[40:43], v[48:51]
    s_waitcnt vmcnt(19)
    buffer_load_dwordx4 v[120:123], v1, s[24:27], s55 offen offset:1024 nt
    v_mov_b32_dpp v11, v44 quad_perm:[0,1,2,3] row_mask:0xf bank_mask:0x1
    v_mov_b32_dpp v12, v45 row_ror:12 row_mask:0xf bank_mask:0x1
    v_mfma_f32_16x16x32_bf16 v[52:55], v[148:151], v[36:39], 0
    s_waitcnt vmcnt(19)
    buffer_load_dwordx4 v[124:127], v1, s[24:27], s55 offen offset:2048 nt
    v_add_f32_dpp v11, v46, v11 row_ror:8 row_mask:0xf bank_mask:0x1
    v_add_f32_dpp v12, v47, v12 row_ror:4 row_mask:0xf bank_mask:0x1
    v_mfma_f32_16x16x32_bf16 v[52:55], v[152:155], v[40:43], v[52:55]
    s_waitcnt vmcnt(19)
    buffer_load_dwordx4 v[128:131], v1, s[24:27], s55 offen offset:3072 nt
    v_mov_b32_dpp v11, v48 row_ror:4 row_mask:0xf bank_mask:0x2
    v_mov_b32_dpp v12, v49 quad_perm:[0,1,2,3] row_mask:0xf bank_mask:0x2
    v_mfma_f32_16x16x32_bf16 v[56:59], v[156:159], v[36:39], 0
    s_add_u32 s55, s54, s74
    s_and_b32 s55, s55, 0x1fffff
    s_waitcnt vmcnt(19)
    buffer_load_dwordx4 v[132:135], v1, s[24:27], s55 offen offset:0 nt
    v_add_f32_dpp v11, v50, v11 row_ror:12 row_mask:0xf bank_mask:0x2
    v_add_f32_dpp v12, v51, v12 row_ror:8 row_mask:0xf bank_mask:0x2
    v_add_u32 v18, 1, v18
    buffer_store_short v18, v17, s[40:43], 0 offen
    v_mfma_f32_16x16x32_bf16 v[56:59], v[160:163], v[40:43], v[56:59]
    s_waitcnt vmcnt(19)
    buffer_load_dwordx4 v[136:139], v1, s[24:27], s55 offen offset:1024 nt
    v_mov_b32_dpp v11, v52 row_ror:8 row_mask:0xf bank_mask:0x4
    v_mov_b32_dpp v12, v53 row_ror:4 row_mask:0xf bank_mask:0x4
    v_mfma_f32_16x16x32_bf16 v[44:47], v[164:167], v[36:39], 0
    s_waitcnt vmcnt(19)
    buffer_load_dwordx4 v[140:143], v1, s[24:27], s55 offen offset:2048 nt
    v_add_f32_dpp v11, v54, v11 quad_perm:[0,1,2,3] row_mask:0xf bank_mask:0x4
    v_add_f32_dpp v12, v55, v12 row_ror:12 row_mask:0xf bank_mask:0x4
    v_mfma_f32_16x16x32_bf16 v[44:47], v[168:171], v[40:43], v[44:47]
    s_waitcnt vmcnt(19)
    buffer_load_dwordx4 v[144:147], v1, s[24:27], s55 offen offset:3072 nt
    v_mov_b32_dpp v11, v56 row_ror:12 row_mask:0xf bank_mask:0x8
    v_mov_b32_dpp v12, v57 row_ror:8 row_mask:0xf bank_mask:0x8
    s_sub_u32 s52, s51, s64
    s_cmp_lt_u32 s52, 3
    s_cbranch_scc1 L_k0_round
L_k0_t:
    v_mfma_f32_16x16x32_bf16 v[48:51], v[172:175], v[36:39], 0
    s_add_u32 s55, s54, s75
    s_and_b32 s55, s55, 0x1fffff
    s_waitcnt vmcnt(19)
    buffer_load_dwordx4 v[148:151], v1, s[24:27], s55 offen offset:0 nt
    v_add_f32_dpp v11, v58, v11 row_ror:4 row_mask:0xf bank_mask:0x8
    v_add_f32_dpp v12, v59, v12 quad_perm:[0,1,2,3] row_mask:0xf bank_mask:0x8
    v_add_f32 v26, v11, v12
    v_mfma_f32_16x16x32_bf16 v[48:51], v[176:179], v[40:43], v[48:51]
    s_waitcnt vmcnt(19)
    buffer_load_dwordx4 v[152:155], v1, s[24:27], s55 offen offset:1024 nt
    v_mov_b32_dpp v11, v44 quad_perm:[0,1,2,3] row_mask:0xf bank_mask:0x1
    v_mov_b32_dpp v12, v45 row_ror:12 row_mask:0xf bank_mask:0x1
    v_mfma_f32_16x16x32_bf16 v[52:55], v[180:183], v[36:39], 0
    s_waitcnt vmcnt(19)
    buffer_load_dwordx4 v[156:159], v1, s[24:27], s55 offen offset:2048 nt
    v_add_f32_dpp v11, v46, v11 row_ror:8 row_mask:0xf bank_mask:0x1
    v_add_f32_dpp v12, v47, v12 row_ror:4 row_mask:0xf bank_mask:0x1
    v_mfma_f32_16x16x32_bf16 v[52:55], v[184:187], v[40:43], v[52:55]
    s_waitcnt vmcnt(19)
    buffer_load_dwordx4 v[160:163], v1, s[24:27], s55 offen offset:3072 nt
    v_mov_b32_dpp v11, v48 row_ror:4 row_mask:0xf bank_mask:0x2
    v_mov_b32_dpp v12, v49 quad_perm:[0,1,2,3] row_mask:0xf bank_mask:0x2
    v_mfma_f32_16x16x32_bf16 v[56:59], v[188:191], v[36:39], 0
    s_add_u32 s55, s54, s76
    s_and_b32 s55, s55, 0x1fffff
    s_waitcnt vmcnt(19)
    buffer_load_dwordx4 v[164:167], v1, s[24:27], s55 offen offset:0 nt
    v_add_f32_dpp v11, v50, v11 row_ror:12 row_mask:0xf bank_mask:0x2
    v_add_f32_dpp v12, v51, v12 row_ror:8 row_mask:0xf bank_mask:0x2
    v_mfma_f32_16x16x32_bf16 v[56:59], v[192:195], v[40:43], v[56:59]
    s_waitcnt vmcnt(19)
    buffer_load_dwordx4 v[168:171], v1, s[24:27], s55 offen offset:1024 nt
    v_mov_b32_dpp v11, v52 row_ror:8 row_mask:0xf bank_mask:0x4
    v_mov_b32_dpp v12, v53 row_ror:4 row_mask:0xf bank_mask:0x4
    s_add_u32 s51, s51, 1
    s_nop 0
    v_add_f32_dpp v11, v54, v11 quad_perm:[0,1,2,3] row_mask:0xf bank_mask:0x4
    v_add_f32_dpp v12, v55, v12 row_ror:12 row_mask:0xf bank_mask:0x4
    s_nop 1
    v_mov_b32_dpp v11, v56 row_ror:12 row_mask:0xf bank_mask:0x8
    v_mov_b32_dpp v12, v57 row_ror:8 row_mask:0xf bank_mask:0x8
    s_cmp_lg_u32 s51, 32
    v_add_f32_dpp v11, v58, v11 row_ror:4 row_mask:0xf bank_mask:0x8
    v_add_f32_dpp v12, v59, v12 quad_perm:[0,1,2,3] row_mask:0xf bank_mask:0x8
    v_add_f32 v27, v11, v12
    v_max3_f32 v10, v10, v24, v25
    v_max3_f32 v10, v10, v26, v27
    ds_write_b128 v3, v[24:27]
    v_add_u32 v3, 1024, v3
    s_cbranch_scc1 L_k0
    s_branch L_mid
.p2align 6
L_k1:
    v_mfma_f32_16x16x32_bf16 v[44:47], v[68:71], v[36:39], 0
    s_waitcnt vmcnt(20)
    buffer_load_dwordx4 v[172:175], v1, s[24:27], s55 offen offset:2048 nt
    s_nop 1
    v_mfma_f32_16x16x32_bf16 v[44:47], v[72:75], v[40:43], v[44:47]
    s_waitcnt vmcnt(20)
    buffer_load_dwordx4 v[176:179], v1, s[24:27], s55 offen offset:3072 nt
    s_nop 1
    v_mfma_f32_16x16x32_bf16 v[48:51], v[76:79], v[36:39], 0
    s_add_u32 s55, s54, s77
    s_and_b32 s55, s55, 0x1fffff
    s_waitcnt vmcnt(20)
    buffer_load_dwordx4 v[180:183], v1, s[24:27], s55 offen offset:0 nt
    s_nop 1
    v_mfma_f32_16x16x32_bf16 v[48:51], v[80:83], v[40:43], v[48:51]
    s_waitcnt vmcnt(20)
    buffer_load_dwordx4 v[184:187], v1, s[24:27], s55 offen offset:1024 nt
    v_mov_b32_dpp v11, v44 quad_perm:[0,1,2,3] row_mask:0xf bank_mask:0x1
    v_mov_b32_dpp v12, v45 row_ror:12 row_mask:0xf bank_mask:0x1
    v_mfma_f32_16x16x32_bf16 v[52:55], v[84:87], v[36:39], 0
    s_waitcnt vmcnt(20)
    buffer_load_dwordx4 v[188:191], v1, s[24:27], s55 offen offset:2048 nt
    v_add_f32_dpp v11, v46, v11 row_ror:8 row_mask:0xf bank_mask:0x1
    v_add_f32_dpp v12, v47, v12 row_ror:4 row_mask:0xf bank_mask:0x1
    v_mfma_f32_16x16x32_bf16 v[52:55], v[88:91], v[40:43], v[52:55]
    s_waitcnt vmcnt(20)
    buffer_load_dwordx4 v[192:195], v1, s[24:27], s55 offen offset:3072 nt
    v_mov_b32_dpp v11, v48 row_ror:4 row_mask:0xf bank_mask:0x2
    v_mov_b32_dpp v12, v49 quad_perm:[0,1,2,3] row_mask:0xf bank_mask:0x2
    v_mfma_f32_16x16x32_bf16 v[56:59], v[92:95], v[36:39], 0
    s_add_u32 s54, s54, 0x10000
    s_cmp_lg_u32 s51, 31
    s_cbranch_scc1 L_k1_same
    s_mov_b64 s[24:25], s[58:59]
    v_mov_b32 v1, v2
L_k1_same:
    s_add_u32 s55, s54, s70
    s_and_b32 s55, s55, 0x1fffff
    s_waitcnt vmcnt(20)
    buffer_load_dwordx4 v[68:71], v1, s[24:27], s55 offen offset:0 nt
    v_add_f32_dpp v11, v50, v11 row_ror:12 row_mask:0xf bank_mask:0x2
    v_add_f32_dpp v12, v51, v12 row_ror:8 row_mask:0xf bank_mask:0x2
    v_mfma_f32_16x16x32_bf16 v[56:59], v[96:99], v[40:43], v[56:59]
    s_waitcnt vmcnt(20)
    buffer_load_dwordx4 v[72:75], v1, s[24:27], s55 offen offset:1024 nt
    v_mov_b32_dpp v11, v52 row_ror:8 row_mask:0xf bank_mask:0x4
    v_mov_b32_dpp v12, v53 row_ror:4 row_mask:0xf bank_mask:0x4
    v_mfma_f32_16x16x32_bf16 v[44:47], v[100:103], v[36:39], 0
    s_waitcnt vmcnt(20)
    buffer_load_dwordx4 v[76:79], v1, s[24:27], s55 offen offset:2048 nt
    v_add_f32_dpp v11, v54, v11 quad_perm:[0,1,2,3] row_mask:0xf bank_mask:0x4
    v_add_f32_dpp v12, v55, v12 row_ror:12 row_mask:0xf bank_mask:0x4
    v_add_u32 v18, 1, v18
    buffer_store_short v18, v17, s[40:43], 0 offen
    v_mfma_f32_16x16x32_bf16 v[44:47], v[104:107], v[40:43], v[44:47]
    s_waitcnt vmcnt(20)
    buffer_load_dwordx4 v[80:83], v1, s[24:27], s55 offen offset:3072 nt
    v_mov_b32_dpp v11, v56 row_ror:12 row_mask:0xf bank_mask:0x8
    v_mov_b32_dpp v12, v57 row_ror:8 row_mask:0xf bank_mask:0x8
    v_mfma_f32_16x16x32_bf16 v[48:51], v[108:111], v[36:39], 0
    s_add_u32 s55, s54, s71
    s_and_b32 s55, s55, 0x1fffff
    s_waitcnt vmcnt(20)
    buffer_load_dwordx4 v[84:87], v1, s[24:27], s55 offen offset:0 nt
    v_add_f32_dpp v11, v58, v11 row_ror:4 row_mask:0xf bank_mask:0x8
    v_add_f32_dpp v12, v59, v12 quad_perm:[0,1,2,3] row_mask:0xf bank_mask:0x8
    v_add_f32 v24, v11, v12
    v_mfma_f32_16x16x32_bf16 v[48:51], v[112:115], v[40:43], v[48:51]
    s_waitcnt vmcnt(20)
    buffer_load_dwordx4 v[88:91], v1, s[24:27], s55 offen offset:1024 nt
    v_mov_b32_dpp v11, v44 quad_perm:[0,1,2,3] row_mask:0xf bank_mask:0x1
    v_mov_b32_dpp v12, v45 row_ror:12 row_mask:0xf bank_mask:0x1
    s_lshl1_add_u32 s52, s51, -1
    s_max_i32 s52, s52, 0
    v_cmp_lt_u32 vcc, s52, v19
    s_and_b32 s60, vcc_lo, 0xffff
    s_bcnt1_i32_b32 s60, s60
    v_cmp_gt_u32 vcc, s52, v19
    s_and_b32 s61, vcc_lo, 0xffff
    s_bcnt1_i32_b32 s61, s61
    v_readlane_b32 s62, v19, s63
    v_mfma_f32_16x16x32_bf16 v[52:55], v[116:119], v[36:39], 0
    s_waitcnt vmcnt(20)
    buffer_load_dwordx4 v[92:95], v1, s[24:27], s55 offen offset:2048 nt
    v_add_f32_dpp v11, v46, v11 row_ror:8 row_mask:0xf bank_mask:0x1
    v_add_f32_dpp v12, v47, v12 row_ror:4 row_mask:0xf bank_mask:0x1
    v_mfma_f32_16x16x32_bf16 v[52:55], v[120:123], v[40:43], v[52:55]
    s_waitcnt vmcnt(20)
    buffer_load_dwordx4 v[96:99], v1, s[24:27], s55 offen offset:3072 nt
    v_mov_b32_dpp v11, v48 row_ror:4 row_mask:0xf bank_mask:0x2
    v_mov_b32_dpp v12, v49 quad_perm:[0,1,2,3] row_mask:0xf bank_mask:0x2
    s_sext_i32_i16 s53, s62
    s_sub_i32 s60, s60, s61
    s_add_i32 s60, s60, s53
    s_cmp_gt_i32 s60, -4
    s_cselect_b32 s67, 1, 0
    s_cmp_gt_i32 s60, -1
    s_cselect_b32 s67, 2, s67
    s_cmp_gt_i32 s60, 2
    s_cselect_b32 s67, 3, s67
    s_cmp_gt_i32 s60, 5
    s_cselect_b32 s67, 4, s67
    v_mfma_f32_16x16x32_bf16 v[56:59], v[124:127], v[36:39], 0
    s_add_u32 s55, s54, s72
    s_and_b32 s55, s55, 0x1fffff
    s_waitcnt vmcnt(20)
    buffer_load_dwordx4 v[100:103], v1, s[24:27], s55 offen offset:0 nt
    v_add_f32_dpp v11, v50, v11 row_ror:12 row_mask:0xf bank_mask:0x2
    v_add_f32_dpp v12, v51, v12 row_ror:8 row_mask:0xf bank_mask:0x2
    s_cmp_lg_u32 s67, 1
    s_cbranch_scc1 L_k_pick
L_k1_u:
    v_mfma_f32_16x16x32_bf16 v[56:59], v[128:131], v[40:43], v[56:59]
    s_waitcnt vmcnt(20)
    buffer_load_dwordx4 v[104:107], v1, s[24:27], s55 offen offset:1024 nt
    v_mov_b32_dpp v11, v52 row_ror:8 row_mask:0xf bank_mask:0x4
    v_mov_b32_dpp v12, v53 row_ror:4 row_mask:0xf bank_mask:0x4
    v_mfma_f32_16x16x32_bf16 v[44:47], v[132:135], v[36:39], 0
    s_waitcnt vmcnt(20)
    buffer_load_dwordx4 v[108:111], v1, s[24:27], s55 offen offset:2048 nt
    v_add_f32_dpp v11, v54, v11 quad_perm:[0,1,2,3] row_mask:0xf bank_mask:0x4
    v_add_f32_dpp v12, v55, v12 row_ror:12 row_mask:0xf bank_mask:0x4
    buffer_load_ushort v19, v17, s[36:39], 0 offen sc1
    v_mfma_f32_16x16x32_bf16 v[44:47], v[136:139], v[40:43], v[44:47]
    s_waitcnt vmcnt(20)
    buffer_load_dwordx4 v[112:115], v1, s[24:27], s55 offen offset:3072 nt
    v_mov_b32_dpp v11, v56 row_ror:12 row_mask:0xf bank_mask:0x8
    v_mov_b32_dpp v12, v57 row_ror:8 row_mask:0xf bank_mask:0x8
    v_mfma_f32_16x16x32_bf16 v[48:51], v[140:143], v[36:39], 0
    s_add_u32 s55, s54, s73
    s_and_b32 s55, s55, 0x1fffff
    s_waitcnt vmcnt(20)
    buffer_load_dwordx4 v[116:119], v1, s[24:27], s55 offen offset:0 nt
    v_add_f32_dpp v11, v58, v11 row_ror:4 row_mask:0xf bank_mask:0x8
    v_add_f32_dpp v12, v59, v12 quad_perm:[0,1,2,3] row_mask:0xf bank_mask:0x8
    v_add_f32 v25, v11, v12
    v_mfma_f32_16x16x32_bf16 v[48:51], v[144:147], v[40:43], v[48:51]
    s_waitcnt vmcnt(20)
    buffer_load_dwordx4 v[120:123], v1, s[24:27], s55 offen offset:1024 nt
    v_mov_b32_dpp v11, v44 quad_perm:[0,1,2,3] row_mask:0xf bank_mask:0x1
    v_mov_b32_dpp v12, v45 row_ror:12 row_mask:0xf bank_mask:0x1
    v_mfma_f32_16x16x32_bf16 v[52:55], v[148:151], v[36:39], 0
    s_waitcnt vmcnt(20)
    buffer_load_dwordx4 v[124:127], v1, s[24:27], s55 offen offset:2048 nt
    v_add_f32_dpp v11, v46, v11 row_ror:8 row_mask:0xf bank_mask:0x1
    v_add_f32_dpp v12, v47, v12 row_ror:4 row_mask:0xf bank_mask:0x1
    v_mfma_f32_16x16x32_bf16 v[52:55], v[152:155], v[40:43], v[52:55]
    s_waitcnt vmcnt(20)
    buffer_load_dwordx4 v[128:131], v1, s[24:27], s55 offen offset:3072 nt
    v_mov_b32_dpp v11, v48 row_ror:4 row_mask:0xf bank_mask:0x2
    v_mov_b32_dpp v12, v49 quad_perm:[0,1,2,3] row_mask:0xf bank_mask:0x2
    v_mfma_f32_16x16x32_bf16 v[56:59], v[156:159], v[36:39], 0
    s_add_u32 s55, s54, s74
    s_and_b32 s55, s55, 0x1fffff
    s_waitcnt vmcnt(20)
    buffer_load_dwordx4 v[132:135], v1, s[24:27], s55 offen offset:0 nt
    v_add_f32_dpp v11, v50, v11 row_ror:12 row_mask:0xf bank_mask:0x2
    v_add_f32_dpp v12, v51, v12 row_ror:8 row_mask:0xf bank_mask:0x2
    v_add_u32 v18, 1, v18
    buffer_store_short v18, v17, s[40:43], 0 offen
    v_mfma_f32_16x16x32_bf16 v[56:59], v[160:163], v[40:43], v[56:59]
    s_waitcnt vmcnt(20)
    buffer_load_dwordx4 v[136:139], v1, s[24:27], s55 offen offset:1024 nt
    v_mov_b32_dpp v11, v52 row_ror:8 row_mask:0xf bank_mask:0x4
    v_mov_b32_dpp v12, v53 row_ror:4 row_mask:0xf bank_mask:0x4
    v_mfma_f32_16x16x32_bf16 v[44:47], v[164:167], v[36:39], 0
    s_waitcnt vmcnt(20)
    buffer_load_dwordx4 v[140:143], v1, s[24:27], s55 offen offset:2048 nt
    v_add_f32_dpp v11, v54, v11 quad_perm:[0,1,2,3] row_mask:0xf bank_mask:0x4
    v_add_f32_dpp v12, v55, v12 row_ror:12 row_mask:0xf bank_mask:0x4
    v_mfma_f32_16x16x32_bf16 v[44:47], v[168:171], v[40:43], v[44:47]
    s_waitcnt vmcnt(20)
    buffer_load_dwordx4 v[144:147], v1, s[24:27], s55 offen offset:3072 nt
    v_mov_b32_dpp v11, v56 row_ror:12 row_mask:0xf bank_mask:0x8
    v_mov_b32_dpp v12, v57 row_ror:8 row_mask:0xf bank_mask:0x8
    s_sub_u32 s52, s51, s64
    s_cmp_lt_u32 s52, 3
    s_cbranch_scc1 L_k1_round
L_k1_t:
    v_mfma_f32_16x16x32_bf16 v[48:51], v[172:175], v[36:39], 0
    s_add_u32 s55, s54, s75
    s_and_b32 s55, s55, 0x1fffff
    s_waitcnt vmcnt(20)
    buffer_load_dwordx4 v[148:151], v1, s[24:27], s55 offen offset:0 nt
    v_add_f32_dpp v11, v58, v11 row_ror:4 row_mask:0xf bank_mask:0x8
    v_add_f32_dpp v12, v59, v12 quad_perm:[0,1,2,3] row_mask:0xf bank_mask:0x8
    v_add_f32 v26, v11, v12
    v_mfma_f32_16x16x32_bf16 v[48:51], v[176:179], v[40:43], v[48:51]
    s_waitcnt vmcnt(20)
    buffer_load_dwordx4 v[152:155], v1, s[24:27], s55 offen offset:1024 nt
    v_mov_b32_dpp v11, v44 quad_perm:[0,1,2,3] row_mask:0xf bank_mask:0x1
    v_mov_b32_dpp v12, v45 row_ror:12 row_mask:0xf bank_mask:0x1
    v_mfma_f32_16x16x32_bf16 v[52:55], v[180:183], v[36:39], 0
    s_waitcnt vmcnt(20)
    buffer_load_dwordx4 v[156:159], v1, s[24:27], s55 offen offset:2048 nt
    v_add_f32_dpp v11, v46, v11 row_ror:8 row_mask:0xf bank_mask:0x1
    v_add_f32_dpp v12, v47, v12 row_ror:4 row_mask:0xf bank_mask:0x1
    v_mfma_f32_16x16x32_bf16 v[52:55], v[184:187], v[40:43], v[52:55]
    s_waitcnt vmcnt(20)
    buffer_load_dwordx4 v[160:163], v1, s[24:27], s55 offen offset:3072 nt
    v_mov_b32_dpp v11, v48 row_ror:4 row_mask:0xf bank_mask:0x2
    v_mov_b32_dpp v12, v49 quad_perm:[0,1,2,3] row_mask:0xf bank_mask:0x2
    v_mfma_f32_16x16x32_bf16 v[56:59], v[188:191], v[36:39], 0
    s_add_u32 s55, s54, s76
    s_and_b32 s55, s55, 0x1fffff
    s_waitcnt vmcnt(20)
    buffer_load_dwordx4 v[164:167], v1, s[24:27], s55 offen offset:0 nt
    v_add_f32_dpp v11, v50, v11 row_ror:12 row_mask:0xf bank_mask:0x2
    v_add_f32_dpp v12, v51, v12 row_ror:8 row_mask:0xf bank_mask:0x2
    v_mfma_f32_16x16x32_bf16 v[56:59], v[192:195], v[40:43], v[56:59]
    s_waitcnt vmcnt(20)
    buffer_load_dwordx4 v[168:171], v1, s[24:27], s55 offen offset:1024 nt
    v_mov_b32_dpp v11, v52 row_ror:8 row_mask:0xf bank_mask:0x4
    v_mov_b32_dpp v12, v53 row_ror:4 row_mask:0xf bank_mask:0x4
    s_add_u32 s51, s51, 1
    s_nop 0
    v_add_f32_dpp v11, v54, v11 quad_perm:[0,1,2,3] row_mask:0xf bank_mask:0x4
    v_add_f32_dpp v12, v55, v12 row_ror:12 row_mask:0xf bank_mask:0x4
    s_nop 1
    v_mov_b32_dpp v11, v56 row_ror:12 row_mask:0xf bank_mask:0x8
    v_mov_b32_dpp v12, v57 row_ror:8 row_mask:0xf bank_mask:0x8
    s_cmp_lg_u32 s51, 32
    v_add_f32_dpp v11, v58, v11 row_ror:4 row_mask:0xf bank_mask:0x8
    v_add_f32_dpp v12, v59, v12 quad_perm:[0,1,2,3] row_mask:0xf bank_mask:0x8
    v_add_f32 v27, v11, v12
    v_max3_f32 v10, v10, v24, v25
    v_max3_f32 v10, v10, v26, v27
    ds_write_b128 v3, v[24:27]
    v_add_u32 v3, 1024, v3
    s_cbranch_scc1 L_k1
    s_branch L_mid
.p2align 6
L_k3:
    v_mfma_f32_16x16x32_bf16 v[44:47], v[68:71], v[36:39], 0
    s_waitcnt vmcnt(22)
    buffer_load_dwordx4 v[172:175], v1, s[24:27], s55 offen offset:2048 nt
    s_nop 1
    v_mfma_f32_16x16x32_bf16 v[44:47], v[72:75], v[40:43], v[44:47]
    s_waitcnt vmcnt(22)
    buffer_load_dwordx4 v[176:179], v1, s[24:27], s55 offen offset:3072 nt
    s_nop 1
    v_mfma_f32_16x16x32_bf16 v[48:51], v[76:79], v[36:39], 0
    s_add_u32 s55, s54, s77
    s_and_b32 s55, s55, 0x1fffff
    s_waitcnt vmcnt(22)
    buffer_load_dwordx4 v[180:183], v1, s[24:27], s55 offen offset:0 nt
    s_nop 1
    v_mfma_f32_16x16x32_bf16 v[48:51], v[80:83], v[40:43], v[48:51]
    s_waitcnt vmcnt(22)
    buffer_load_dwordx4 v[184:187], v1, s[24:27], s55 offen offset:1024 nt
    v_mov_b32_dpp v11, v44 quad_perm:[0,1,2,3] row_mask:0xf bank_mask:0x1
    v_mov_b32_dpp v12, v45 row_ror:12 row_mask:0xf bank_mask:0x1
    v_mfma_f32_16x16x32_bf16 v[52:55], v[84:87], v[36:39], 0
    s_waitcnt vmcnt(22)
    buffer_load_dwordx4 v[188:191], v1, s[24:27], s55 offen offset:2048 nt
    v_add_f32_dpp v11, v46, v11 row_ror:8 row_mask:0xf bank_mask:0x1
    v_add_f32_dpp v12, v47, v12 row_ror:4 row_mask:0xf bank_mask:0x1
    v_mfma_f32_16x16x32_bf16 v[52:55], v[88:91], v[40:43], v[52:55]
    s_waitcnt vmcnt(22)
    buffer_load_dwordx4 v[192:195], v1, s[24:27], s55 offen offset:3072 nt
    v_mov_b32_dpp v11, v48 row_ror:4 row_mask:0xf bank_mask:0x2
    v_mov_b32_dpp v12, v49 quad_perm:[0,1,2,3] row_mask:0xf bank_mask:0x2
    v_mfma_f32_16x16x32_bf16 v[56:59], v[92:95], v[36:39], 0
    s_add_u32 s54, s54, 0x10000
    s_cmp_lg_u32 s51, 31
    s_cbranch_scc1 L_k3_same
    s_mov_b64 s[24:25], s[58:59]
    v_mov_b32 v1, v2
L_k3_same:
    s_add_u32 s55, s54, s70
    s_and_b32 s55, s55, 0x1fffff
    s_waitcnt vmcnt(22)
    buffer_load_dwordx4 v[68:71], v1, s[24:27], s55 offen offset:0 nt
    v_add_f32_dpp v11, v50, v11 row_ror:12 row_mask:0xf bank_mask:0x2
    v_add_f32_dpp v12, v51, v12 row_ror:8 row_mask:0xf bank_mask:0x2
    v_mfma_f32_16x16x32_bf16 v[56:59], v[96:99], v[40:43], v[56:59]
    s_waitcnt vmcnt(22)
    buffer_load_dwordx4 v[72:75], v1, s[24:27], s55 offen offset:1024 nt
    v_mov_b32_dpp v11, v52 row_ror:8 row_mask:0xf bank_mask:0x4
    v_mov_b32_dpp v12, v53 row_ror:4 row_mask:0xf bank_mask:0x4
    v_mfma_f32_16x16x32_bf16 v[44:47], v[100:103], v[36:39], 0
    s_waitcnt vmcnt(22)
    buffer_load_dwordx4 v[76:79], v1, s[24:27], s55 offen offset:2048 nt
    v_add_f32_dpp v11, v54, v11 quad_perm:[0,1,2,3] row_mask:0xf bank_mask:0x4
    v_add_f32_dpp v12, v55, v12 row_ror:12 row_mask:0xf bank_mask:0x4
    v_add_u32 v18, 1, v18
    buffer_store_short v18, v17, s[40:43], 0 offen
    v_mfma_f32_16x16x32_bf16 v[44:47], v[104:107], v[40:43], v[44:47]
    s_waitcnt vmcnt(22)
    buffer_load_dwordx4 v[80:83], v1, s[24:27], s55 offen offset:3072 nt
    v_mov_b32_dpp v11, v56 row_ror:12 row_mask:0xf bank_mask:0x8
    v_mov_b32_dpp v12, v57 row_ror:8 row_mask:0xf bank_mask:0x8
    v_mfma_f32_16x16x32_bf16 v[48:51], v[108:111], v[36:39], 0
    s_add_u32 s55, s54, s71
    s_and_b32 s55, s55, 0x1fffff
    s_waitcnt vmcnt(22)
    buffer_load_dwordx4 v[84:87], v1, s[24:27], s55 offen offset:0 nt
    v_add_f32_dpp v11, v58, v11 row_ror:4 row_mask:0xf bank_mask:0x8
    v_add_f32_dpp v12, v59, v12 quad_perm:[0,1,2,3] row_mask:0xf bank_mask:0x8
    v_add_f32 v24, v11, v12
    v_mfma_f32_16x16x32_bf16 v[48:51], v[112:115], v[40:43], v[48:51]
    s_waitcnt vmcnt(22)
    buffer_load_dwordx4 v[88:91], v1, s[24:27], s55 offen offset:1024 nt
    v_mov_b32_dpp v11, v44 quad_perm:[0,1,2,3] row_mask:0xf bank_mask:0x1
    v_mov_b32_dpp v12, v45 row_ror:12 row_mask:0xf bank_mask:0x1
    s_lshl1_add_u32 s52, s51, -1
    s_max_i32 s52, s52, 0
    v_cmp_lt_u32 vcc, s52, v19
    s_and_b32 s60, vcc_lo, 0xffff
    s_bcnt1_i32_b32 s60, s60
    v_cmp_gt_u32 vcc, s52, v19
    s_and_b32 s61, vcc_lo, 0xffff
    s_bcnt1_i32_b32 s61, s61
    v_readlane_b32 s62, v19, s63
    v_mfma_f32_16x16x32_bf16 v[52:55], v[116:119], v[36:39], 0
    s_waitcnt vmcnt(22)
    buffer_load_dwordx4 v[92:95], v1, s[24:27], s55 offen offset:2048 nt
    v_add_f32_dpp v11, v46, v11 row_ror:8 row_mask:0xf bank_mask:0x1
    v_add_f32_dpp v12, v47, v12 row_ror:4 row_mask:0xf bank_mask:0x1
    v_mfma_f32_16x16x32_bf16 v[52:55], v[120:123], v[40:43], v[52:55]
    s_waitcnt vmcnt(22)
    buffer_load_dwordx4 v[96:99], v1, s[24:27], s55 offen offset:3072 nt
    v_mov_b32_dpp v11, v48 row_ror:4 row_mask:0xf bank_mask:0x2
    v_mov_b32_dpp v12, v49 quad_perm:[0,1,2,3] row_mask:0xf bank_mask:0x2
    s_sext_i32_i16 s53, s62
    s_sub_i32 s60, s60, s61
    s_add_i32 s60, s60, s53
    s_cmp_gt_i32 s60, -4
    s_cselect_b32 s67, 1, 0
    s_cmp_gt_i32 s60, -1
    s_cselect_b32 s67, 2, s67
    s_cmp_gt_i32 s60, 2
    s_cselect_b32 s67, 3, s67
    s_cmp_gt_i32 s60, 5
    s_cselect_b32 s67, 4, s67
    v_mfma_f32_16x16x32_bf16 v[56:59], v[124:127], v[36:39], 0
    s_add_u32 s55, s54, s72
    s_and_b32 s55, s55, 0x1fffff
    s_waitcnt vmcnt(22)
    buffer_load_dwordx4 v[100:103], v1, s[24:27], s55 offen offset:0 nt
    v_add_f32_dpp v11, v50, v11 row_ror:12 row_mask:0xf bank_mask:0x2
    v_add_f32_dpp v12, v51, v12 row_ror:8 row_mask:0xf bank_mask:0x2
    s_cmp_lg_u32 s67, 3
    s_cbranch_scc1 L_k_pick
L_k3_u:
    v_mfma_f32_16x16x32_bf16 v[56:59], v[128:131], v[40:43], v[56:59]
    s_waitcnt vmcnt(22)
    buffer_load_dwordx4 v[104:107], v1, s[24:27], s55 offen offset:1024 nt
    v_mov_b32_dpp v11, v52 row_ror:8 row_mask:0xf bank_mask:0x4
    v_mov_b32_dpp v12, v53 row_ror:4 row_mask:0xf bank_mask:0x4
    v_mfma_f32_16x16x32_bf16 v[44:47], v[132:135], v[36:39], 0
    s_waitcnt vmcnt(22)
    buffer_load_dwordx4 v[108:111], v1, s[24:27], s55 offen offset:2048 nt
    v_add_f32_dpp v11, v54, v11 quad_perm:[0,1,2,3] row_mask:0xf bank_mask:0x4
    v_add_f32_dpp v12, v55, v12 row_ror:12 row_mask:0xf bank_mask:0x4
    buffer_load_ushort v19, v17, s[36:39], 0 offen sc1
    v_mfma_f32_16x16x32_bf16 v[44:47], v[136:139], v[40:43], v[44:47]
    s_waitcnt vmcnt(22)
    buffer_load_dwordx4 v[112:115], v1, s[24:27], s55 offen offset:3072 nt
    v_mov_b32_dpp v11, v56 row_ror:12 row_mask:0xf bank_mask:0x8
    v_mov_b32_dpp v12, v57 row_ror:8 row_mask:0xf bank_mask:0x8
    v_mfma_f32_16x16x32_bf16 v[48:51], v[140:143], v[36:39], 0
    s_add_u32 s55, s54, s73
    s_and_b32 s55, s55, 0x1fffff
    s_waitcnt vmcnt(22)
    buffer_load_dwordx4 v[116:119], v1, s[24:27], s55 offen offset:0 nt
    v_add_f32_dpp v11, v58, v11 row_ror:4 row_mask:0xf bank_mask:0x8
    v_add_f32_dpp v12, v59, v12 quad_perm:[0,1,2,3] row_mask:0xf bank_mask:0x8
    v_add_f32 v25, v11, v12
    v_mfma_f32_16x16x32_bf16 v[48:51], v[144:147], v[40:43], v[48:51]
    s_waitcnt vmcnt(22)
    buffer_load_dwordx4 v[120:123], v1, s[24:27], s55 offen offset:1024 nt
    v_mov_b32_dpp v11, v44 quad_perm:[0,1,2,3] row_mask:0xf bank_mask:0x1
    v_mov_b32_dpp v12, v45 row_ror:12 row_mask:0xf bank_mask:0x1
    v_mfma_f32_16x16x32_bf16 v[52:55], v[148:151], v[36:39], 0
    s_waitcnt vmcnt(22)
    buffer_load_dwordx4 v[124:127], v1, s[24:27], s55 offen offset:2048 nt
    v_add_f32_dpp v11, v46, v11 row_ror:8 row_mask:0xf bank_mask:0x1
    v_add_f32_dpp v12, v47, v12 row_ror:4 row_mask:0xf bank_mask:0x1
    v_mfma_f32_16x16x32_bf16 v[52:55], v[152:155], v[40:43], v[52:55]
    s_waitcnt vmcnt(22)
    buffer_load_dwordx4 v[128:131], v1, s[24:27], s55 offen offset:3072 nt
    v_mov_b32_dpp v11, v48 row_ror:4 row_mask:0xf bank_mask:0x2
    v_mov_b32_dpp v12, v49 quad_perm:[0,1,2,3] row_mask:0xf bank_mask:0x2
    v_mfma_f32_16x16x32_bf16 v[56:59], v[156:159], v[36:39], 0
    s_add_u32 s55, s54, s74
    s_and_b32 s55, s55, 0x1fffff
    s_waitcnt vmcnt(22)
    buffer_load_dwordx4 v[132:135], v1, s[24:27], s55 offen offset:0 nt
    v_add_f32_dpp v11, v50, v11 row_ror:12 row_mask:0xf bank_mask:0x2
    v_add_f32_dpp v12, v51, v12 row_ror:8 row_mask:0xf bank_mask:0x2
    v_add_u32 v18, 1, v18
    buffer_store_short v18, v17, s[40:43], 0 offen
    v_mfma_f32_16x16x32_bf16 v[56:59], v[160:163], v[40:43], v[56:59]
    s_waitcnt vmcnt(22)
    buffer_load_dwordx4 v[136:139], v1, s[24:27], s55 offen offset:1024 nt
    v_mov_b32_dpp v11, v52 row_ror:8 row_mask:0xf bank_mask:0x4
    v_mov_b32_dpp v12, v53 row_ror:4 row_mask:0xf bank_mask:0x4
    v_mfma_f32_16x16x32_bf16 v[44:47], v[164:167], v[36:39], 0
    s_waitcnt vmcnt(22)
    buffer_load_dwordx4 v[140:143], v1, s[24:27], s55 offen offset:2048 nt
    v_add_f32_dpp v11, v54, v11 quad_perm:[0,1,2,3] row_mask:0xf bank_mask:0x4
    v_add_f32_dpp v12, v55, v12 row_ror:12 row_mask:0xf bank_mask:0x4
    v_mfma_f32_16x16x32_bf16 v[44:47], v[168:171], v[40:43], v[44:47]
    s_waitcnt vmcnt(22)
    buffer_load_dwordx4 v[144:147], v1, s[24:27], s55 offen offset:3072 nt
    v_mov_b32_dpp v11, v56 row_ror:12 row_mask:0xf bank_mask:0x8
    v_mov_b32_dpp v12, v57 row_ror:8 row_mask:0xf bank_mask:0x8
    s_sub_u32 s52, s51, s64
    s_cmp_lt_u32 s52, 3
    s_cbranch_scc1 L_k3_round
L_k3_t:
    v_mfma_f32_16x16x32_bf16 v[48:51], v[172:175], v[36:39], 0
    s_add_u32 s55, s54, s75
    s_and_b32 s55, s55, 0x1fffff
    s_waitcnt vmcnt(22)
    buffer_load_dwordx4 v[148:151], v1, s[24:27], s55 offen offset:0 nt
    v_add_f32_dpp v11, v58, v11 row_ror:4 row_mask:0xf bank_mask:0x8
    v_add_f32_dpp v12, v59, v12 quad_perm:[0,1,2,3] row_mask:0xf bank_mask:0x8
    v_add_f32 v26, v11, v12
    v_mfma_f32_16x16x32_bf16 v[48:51], v[176:179], v[40:43], v[48:51]
    s_waitcnt vmcnt(22)
    buffer_load_dwordx4 v[152:155], v1, s[24:27], s55 offen offset:1024 nt
    v_mov_b32_dpp v11, v44 quad_perm:[0,1,2,3] row_mask:0xf bank_mask:0x1
    v_mov_b32_dpp v12, v45 row_ror:12 row_mask:0xf bank_mask:0x1
    v_mfma_f32_16x16x32_bf16 v[52:55], v[180:183], v[36:39], 0
    s_waitcnt vmcnt(22)
    buffer_load_dwordx4 v[156:159], v1, s[24:27], s55 offen offset:2048 nt
    v_add_f32_dpp v11, v46, v11 row_ror:8 row_mask:0xf bank_mask:0x1
    v_add_f32_dpp v12, v47, v12 row_ror:4 row_mask:0xf bank_mask:0x1
    v_mfma_f32_16x16x32_bf16 v[52:55], v[184:187], v[40:43], v[52:55]
    s_waitcnt vmcnt(22)
    buffer_load_dwordx4 v[160:163], v1, s[24:27], s55 offen offset:3072 nt
    v_mov_b32_dpp v11, v48 row_ror:4 row_mask:0xf bank_mask:0x2
    v_mov_b32_dpp v12, v49 quad_perm:[0,1,2,3] row_mask:0xf bank_mask:0x2
    v_mfma_f32_16x16x32_bf16 v[56:59], v[188:191], v[36:39], 0
    s_add_u32 s55, s54, s76
    s_and_b32 s55, s55, 0x1fffff
    s_waitcnt vmcnt(22)
    buffer_load_dwordx4 v[164:167], v1, s[24:27], s55 offen offset:0 nt
    v_add_f32_dpp v11, v50, v11 row_ror:12 row_mask:0xf bank_mask:0x2
    v_add_f32_dpp v12, v51, v12 row_ror:8 row_mask:0xf bank_mask:0x2
    v_mfma_f32_16x16x32_bf16 v[56:59], v[192:195], v[40:43], v[56:59]
    s_waitcnt vmcnt(22)
    buffer_load_dwordx4 v[168:171], v1, s[24:27], s55 offen offset:1024 nt
    v_mov_b32_dpp v11, v52 row_ror:8 row_mask:0xf bank_mask:0x4
    v_mov_b32_dpp v12, v53 row_ror:4 row_mask:0xf bank_mask:0x4
    s_add_u32 s51, s51, 1
    s_nop 0
    v_add_f32_dpp v11, v54, v11 quad_perm:[0,1,2,3] row_mask:0xf bank_mask:0x4
    v_add_f32_dpp v12, v55, v12 row_ror:12 row_mask:0xf bank_mask:0x4
    s_nop 1
    v_mov_b32_dpp v11, v56 row_ror:12 row_mask:0xf bank_mask:0x8
    v_mov_b32_dpp v12, v57 row_ror:8 row_mask:0xf bank_mask:0x8
    s_cmp_lg_u32 s51, 32
    v_add_f32_dpp v11, v58, v11 row_ror:4 row_mask:0xf bank_mask:0x8
    v_add_f32_dpp v12, v59, v12 quad_perm:[0,1,2,3] row_mask:0xf bank_mask:0x8
    v_add_f32 v27, v11, v12
    v_max3_f32 v10, v10, v24, v25
    v_max3_f32 v10, v10, v26, v27
    ds_write_b128 v3, v[24:27]
    v_add_u32 v3, 1024, v3
    s_cbranch_scc1 L_k3
    s_branch L_mid
.p2align 6
L_k4:
    v_mfma_f32_16x16x32_bf16 v[44:47], v[68:71], v[36:39], 0
    s_waitcnt vmcnt(24)
    buffer_load_dwordx4 v[172:175], v1, s[24:27], s55 offen offset:2048 nt
    s_nop 1
    v_mfma_f32_16x16x32_bf16 v[44:47], v[72:75], v[40:43], v[44:47]
    s_waitcnt vmcnt(24)
    buffer_load_dwordx4 v[176:179], v1, s[24:27], s55 offen offset:3072 nt
    s_nop 1
    v_mfma_f32_16x16x32_bf16 v[48:51], v[76:79], v[36:39], 0
    s_add_u32 s55, s54, s77
    s_and_b32 s55, s55, 0x1fffff
    s_waitcnt vmcnt(24)
    buffer_load_dwordx4 v[180:183], v1, s[24:27], s55 offen offset:0 nt
    s_nop 1
    v_mfma_f32_16x16x32_bf16 v[48:51], v[80:83], v[40:43], v[48:51]
    s_waitcnt vmcnt(24)
    buffer_load_dwordx4 v[184:187], v1, s[24:27], s55 offen offset:1024 nt
    v_mov_b32_dpp v11, v44 quad_perm:[0,1,2,3] row_mask:0xf bank_mask:0x1
    v_mov_b32_dpp v12, v45 row_ror:12 row_mask:0xf bank_mask:0x1
    v_mfma_f32_16x16x32_bf16 v[52:55], v[84:87], v[36:39], 0
    s_waitcnt vmcnt(24)
    buffer_load_dwordx4 v[188:191], v1, s[24:27], s55 offen offset:2048 nt
    v_add_f32_dpp v11, v46, v11 row_ror:8 row_mask:0xf bank_mask:0x1
    v_add_f32_dpp v12, v47, v12 row_ror:4 row_mask:0xf bank_mask:0x1
    v_mfma_f32_16x16x32_bf16 v[52:55], v[88:91], v[40:43], v[52:55]
    s_waitcnt vmcnt(24)
    buffer_load_dwordx4 v[192:195], v1, s[24:27], s55 offen offset:3072 nt
    v_mov_b32_dpp v11, v48 row_ror:4 row_mask:0xf bank_mask:0x2
    v_mov_b32_dpp v12, v49 quad_perm:[0,1,2,3] row_mask:0xf bank_mask:0x2
    v_mfma_f32_16x16x32_bf16 v[56:59], v[92:95], v[36:39], 0
    s_add_u32 s54, s54, 0x10000
    s_cmp_lg_u32 s51, 31
    s_cbranch_scc1 L_k4_same
    s_mov_b64 s[24:25], s[58:59]
    v_mov_b32 v1, v2
L_k4_same:
    s_add_u32 s55, s54, s70
    s_and_b32 s55, s55, 0x1fffff
    s_waitcnt vmcnt(24)
    buffer_load_dwordx4 v[68:71], v1, s[24:27], s55 offen offset:0 nt
    v_add_f32_dpp v11, v50, v11 row_ror:12 row_mask:0xf bank_mask:0x2
    v_add_f32_dpp v12, v51, v12 row_ror:8 row_mask:0xf bank_mask:0x2
    v_mfma_f32_16x16x32_bf16 v[56:59], v[96:99], v[40:43], v[56:59]
    s_waitcnt vmcnt(24)
    buffer_load_dwordx4 v[72:75], v1, s[24:27], s55 offen offset:1024 nt
    v_mov_b32_dpp v11, v52 row_ror:8 row_mask:0xf bank_mask:0x4
    v_mov_b32_dpp v12, v53 row_ror:4 row_mask:0xf bank_mask:0x4
    v_mfma_f32_16x16x32_bf16 v[44:47], v[100:103], v[36:39], 0
    s_waitcnt vmcnt(24)
    buffer_load_dwordx4 v[76:79], v1, s[24:27], s55 offen offset:2048 nt
    v_add_f32_dpp v11, v54, v11 quad_perm:[0,1,2,3] row_mask:0xf bank_mask:0x4
    v_add_f32_dpp v12, v55, v12 row_ror:12 row_mask:0xf bank_mask:0x4
    v_add_u32 v18, 1, v18
    buffer_store_short v18, v17, s[40:43], 0 offen
    v_mfma_f32_16x16x32_bf16 v[44:47], v[104:107], v[40:43], v[44:47]
    s_waitcnt vmcnt(24)
    buffer_load_dwordx4 v[80:83], v1, s[24:27], s55 offen offset:3072 nt
    v_mov_b32_dpp v11, v56 row_ror:12 row_mask:0xf bank_mask:0x8
    v_mov_b32_dpp v12, v57 row_ror:8 row_mask:0xf bank_mask:0x8
    v_mfma_f32_16x16x32_bf16 v[48:51], v[108:111], v[36:39], 0
    s_add_u32 s55, s54, s71
    s_and_b32 s55, s55, 0x1fffff
    s_waitcnt vmcnt(24)
    buffer_load_dwordx4 v[84:87], v1, s[24:27], s55 offen offset:0 nt
    v_add_f32_dpp v11, v58, v11 row_ror:4 row_mask:0xf bank_mask:0x8
    v_add_f32_dpp v12, v59, v12 quad_perm:[0,1,2,3] row_mask:0xf bank_mask:0x8
    v_add_f32 v24, v11, v12
    v_mfma_f32_16x16x32_bf16 v[48:51], v[112:115], v[40:43], v[48:51]
    s_waitcnt vmcnt(24)
    buffer_load_dwordx4 v[88:91], v1, s[24:27], s55 offen offset:1024 nt
    v_mov_b32_dpp v11, v44 quad_perm:[0,1,2,3] row_mask:0xf bank_mask:0x1
    v_mov_b32_dpp v12, v45 row_ror:12 row_mask:0xf bank_mask:0x1
    s_lshl1_add_u32 s52, s51, -1
    s_max_i32 s52, s52, 0
    v_cmp_lt_u32 vcc, s52, v19
    s_and_b32 s60, vcc_lo, 0xffff
    s_bcnt1_i32_b32 s60, s60
    v_cmp_gt_u32 vcc, s52, v19
    s_and_b32 s61, vcc_lo, 0xffff
    s_bcnt1_i32_b32 s61, s61
    v_readlane_b32 s62, v19, s63
    v_mfma_f32_16x16x32_bf16 v[52:55], v[116:119], v[36:39], 0
    s_waitcnt vmcnt(24)
    buffer_load_dwordx4 v[92:95], v1, s[24:27], s55 offen offset:2048 nt
    v_add_f32_dpp v11, v46, v11 row_ror:8 row_mask:0xf bank_mask:0x1
    v_add_f32_dpp v12, v47, v12 row_ror:4 row_mask:0xf bank_mask:0x1
    v_mfma_f32_16x16x32_bf16 v[52:55], v[120:123], v[40:43], v[52:55]
    s_waitcnt vmcnt(24)
    buffer_load_dwordx4 v[96:99], v1, s[24:27], s55 offen offset:3072 nt
    v_mov_b32_dpp v11, v48 row_ror:4 row_mask:0xf bank_mask:0x2
    v_mov_b32_dpp v12, v49 quad_perm:[0,1,2,3] row_mask:0xf bank_mask:0x2
    s_sext_i32_i16 s53, s62
    s_sub_i32 s60, s60, s61
    s_add_i32 s60, s60, s53
    s_cmp_gt_i32 s60, -4
    s_cselect_b32 s67, 1, 0
    s_cmp_gt_i32 s60, -1
    s_cselect_b32 s67, 2, s67
    s_cmp_gt_i32 s60, 2
    s_cselect_b32 s67, 3, s67
    s_cmp_gt_i32 s60, 5
    s_cselect_b32 s67, 4, s67
    v_mfma_f32_16x16x32_bf16 v[56:59], v[124:127], v[36:39], 0
    s_add_u32 s55, s54, s72
    s_and_b32 s55, s55, 0x1fffff
    s_waitcnt vmcnt(24)
    buffer_load_dwordx4 v[100:103], v1, s[24:27], s55 offen offset:0 nt
    v_add_f32_dpp v11, v50, v11 row_ror:12 row_mask:0xf bank_mask:0x2
    v_add_f32_dpp v12, v51, v12 row_ror:8 row_mask:0xf bank_mask:0x2
    s_cmp_lg_u32 s67, 4
    s_cbranch_scc1 L_k_pick
L_k4_u:
    v_mfma_f32_16x16x32_bf16 v[56:59], v[128:131], v[40:43], v[56:59]
    s_waitcnt vmcnt(24)
    buffer_load_dwordx4 v[104:107], v1, s[24:27], s55 offen offset:1024 nt
    v_mov_b32_dpp v11, v52 row_ror:8 row_mask:0xf bank_mask:0x4
    v_mov_b32_dpp v12, v53 row_ror:4 row_mask:0xf bank_mask:0x4
    v_mfma_f32_16x16x32_bf16 v[44:47], v[132:135], v[36:39], 0
    s_waitcnt vmcnt(24)
    buffer_load_dwordx4 v[108:111], v1, s[24:27], s55 offen offset:2048 nt
    v_add_f32_dpp v11, v54, v11 quad_perm:[0,1,2,3] row_mask:0xf bank_mask:0x4
    v_add_f32_dpp v12, v55, v12 row_ror:12 row_mask:0xf bank_mask:0x4
    buffer_load_ushort v19, v17, s[36:39], 0 offen sc1
    v_mfma_f32_16x16x32_bf16 v[44:47], v[136:139], v[40:43], v[44:47]
    s_waitcnt vmcnt(24)
    buffer_load_dwordx4 v[112:115], v1, s[24:27], s55 offen offset:3072 nt
    v_mov_b32_dpp v11, v56 row_ror:12 row_mask:0xf bank_mask:0x8
    v_mov_b32_dpp v12, v57 row_ror:8 row_mask:0xf bank_mask:0x8
    v_mfma_f32_16x16x32_bf16 v[48:51], v[140:143], v[36:39], 0
    s_add_u32 s55, s54, s73
    s_and_b32 s55, s55, 0x1fffff
    s_waitcnt vmcnt(24)
    buffer_load_dwordx4 v[116:119], v1, s[24:27], s55 offen offset:0 nt
    v_add_f32_dpp v11, v58, v11 row_ror:4 row_mask:0xf bank_mask:0x8
    v_add_f32_dpp v12, v59, v12 quad_perm:[0,1,2,3] row_mask:0xf bank_mask:0x8
    v_add_f32 v25, v11, v12
    v_mfma_f32_16x16x32_bf16 v[48:51], v[144:147], v[40:43], v[48:51]
    s_waitcnt vmcnt(24)
    buffer_load_dwordx4 v[120:123], v1, s[24:27], s55 offen offset:1024 nt
    v_mov_b32_dpp v11, v44 quad_perm:[0,1,2,3] row_mask:0xf bank_mask:0x1
    v_mov_b32_dpp v12, v45 row_ror:12 row_mask:0xf bank_mask:0x1
    v_mfma_f32_16x16x32_bf16 v[52:55], v[148:151], v[36:39], 0
    s_waitcnt vmcnt(24)
    buffer_load_dwordx4 v[124:127], v1, s[24:27], s55 offen offset:2048 nt
    v_add_f32_dpp v11, v46, v11 row_ror:8 row_mask:0xf bank_mask:0x1
    v_add_f32_dpp v12, v47, v12 row_ror:4 row_mask:0xf bank_mask:0x1
    v_mfma_f32_16x16x32_bf16 v[52:55], v[152:155], v[40:43], v[52:55]
    s_waitcnt vmcnt(24)
    buffer_load_dwordx4 v[128:131], v1, s[24:27], s55 offen offset:3072 nt
    v_mov_b32_dpp v11, v48 row_ror:4 row_mask:0xf bank_mask:0x2
    v_mov_b32_dpp v12, v49 quad_perm:[0,1,2,3] row_mask:0xf bank_mask:0x2
    v_mfma_f32_16x16x32_bf16 v[56:59], v[156:159], v[36:39], 0
    s_add_u32 s55, s54, s74
    s_and_b32 s55, s55, 0x1fffff
    s_waitcnt vmcnt(24)
    buffer_load_dwordx4 v[132:135], v1, s[24:27], s55 offen offset:0 nt
    v_add_f32_dpp v11, v50, v11 row_ror:12 row_mask:0xf bank_mask:0x2
    v_add_f32_dpp v12, v51, v12 row_ror:8 row_mask:0xf bank_mask:0x2
    v_add_u32 v18, 1, v18
    buffer_store_short v18, v17, s[40:43], 0 offen
    v_mfma_f32_16x16x32_bf16 v[56:59], v[160:163], v[40:43], v[56:59]
    s_waitcnt vmcnt(24)
    buffer_load_dwordx4 v[136:139], v1, s[24:27], s55 offen offset:1024 nt
    v_mov_b32_dpp v11, v52 row_ror:8 row_mask:0xf bank_mask:0x4
    v_mov_b32_dpp v12, v53 row_ror:4 row_mask:0xf bank_mask:0x4
    v_mfma_f32_16x16x32_bf16 v[44:47], v[164:167], v[36:39], 0
    s_waitcnt vmcnt(24)
    buffer_load_dwordx4 v[140:143], v1, s[24:27], s55 offen offset:2048 nt
    v_add_f32_dpp v11, v54, v11 quad_perm:[0,1,2,3] row_mask:0xf bank_mask:0x4
    v_add_f32_dpp v12, v55, v12 row_ror:12 row_mask:0xf bank_mask:0x4
    v_mfma_f32_16x16x32_bf16 v[44:47], v[168:171], v[40:43], v[44:47]
    s_waitcnt vmcnt(24)
    buffer_load_dwordx4 v[144:147], v1, s[24:27], s55 offen offset:3072 nt
    v_mov_b32_dpp v11, v56 row_ror:12 row_mask:0xf bank_mask:0x8
    v_mov_b32_dpp v12, v57 row_ror:8 row_mask:0xf bank_mask:0x8
    s_sub_u32 s52, s51, s64
    s_cmp_lt_u32 s52, 3
    s_cbranch_scc1 L_k4_round
L_k4_t:
    v_mfma_f32_16x16x32_bf16 v[48:51], v[172:175], v[36:39], 0
    s_add_u32 s55, s54, s75
    s_and_b32 s55, s55, 0x1fffff
    s_waitcnt vmcnt(24)
    buffer_load_dwordx4 v[148:151], v1, s[24:27], s55 offen offset:0 nt
    v_add_f32_dpp v11, v58, v11 row_ror:4 row_mask:0xf bank_mask:0x8
    v_add_f32_dpp v12, v59, v12 quad_perm:[0,1,2,3] row_mask:0xf bank_mask:0x8
    v_add_f32 v26, v11, v12
    v_mfma_f32_16x16x32_bf16 v[48:51], v[176:179], v[40:43], v[48:51]
    s_waitcnt vmcnt(24)
    buffer_load_dwordx4 v[152:155], v1, s[24:27], s55 offen offset:1024 nt
    v_mov_b32_dpp v11, v44 quad_perm:[0,1,2,3] row_mask:0xf bank_mask:0x1
    v_mov_b32_dpp v12, v45 row_ror:12 row_mask:0xf bank_mask:0x1
    v_mfma_f32_16x16x32_bf16 v[52:55], v[180:183], v[36:39], 0
    s_waitcnt vmcnt(24)
    buffer_load_dwordx4 v[156:159], v1, s[24:27], s55 offen offset:2048 nt
    v_add_f32_dpp v11, v46, v11 row_ror:8 row_mask:0xf bank_mask:0x1
    v_add_f32_dpp v12, v47, v12 row_ror:4 row_mask:0xf bank_mask:0x1
    v_mfma_f32_16x16x32_bf16 v[52:55], v[184:187], v[40:43], v[52:55]
    s_waitcnt vmcnt(24)
    buffer_load_dwordx4 v[160:163], v1, s[24:27], s55 offen offset:3072 nt
    v_mov_b32_dpp v11, v48 row_ror:4 row_mask:0xf bank_mask:0x2
    v_mov_b32_dpp v12, v49 quad_perm:[0,1,2,3] row_mask:0xf bank_mask:0x2
    v_mfma_f32_16x16x32_bf16 v[56:59], v[188:191], v[36:39], 0
    s_add_u32 s55, s54, s76
    s_and_b32 s55, s55, 0x1fffff
    s_waitcnt vmcnt(24)
    buffer_load_dwordx4 v[164:167], v1, s[24:27], s55 offen offset:0 nt
    v_add_f32_dpp v11, v50, v11 row_ror:12 row_mask:0xf bank_mask:0x2
    v_add_f32_dpp v12, v51, v12 row_ror:8 row_mask:0xf bank_mask:0x2
    v_mfma_f32_16x16x32_bf16 v[56:59], v[192:195], v[40:43], v[56:59]
    s_waitcnt vmcnt(24)
    buffer_load_dwordx4 v[168:171], v1, s[24:27], s55 offen offset:1024 nt
    v_mov_b32_dpp v11, v52 row_ror:8 row_mask:0xf bank_mask:0x4
    v_mov_b32_dpp v12, v53 row_ror:4 row_mask:0xf bank_mask:0x4
    s_add_u32 s51, s51, 1
    s_nop 0
    v_add_f32_dpp v11, v54, v11 quad_perm:[0,1,2,3] row_mask:0xf bank_mask:0x4
    v_add_f32_dpp v12, v55, v12 row_ror:12 row_mask:0xf bank_mask:0x4
    s_nop 1
    v_mov_b32_dpp v11, v56 row_ror:12 row_mask:0xf bank_mask:0x8
    v_mov_b32_dpp v12, v57 row_ror:8 row_mask:0xf bank_mask:0x8
    s_cmp_lg_u32 s51, 32
    v_add_f32_dpp v11, v58, v11 row_ror:4 row_mask:0xf bank_mask:0x8
    v_add_f32_dpp v12, v59, v12 quad_perm:[0,1,2,3] row_mask:0xf bank_mask:0x8
    v_add_f32 v27, v11, v12
    v_max3_f32 v10, v10, v24, v25
    v_max3_f32 v10, v10, v26, v27
    ds_write_b128 v3, v[24:27]
    v_add_u32 v3, 1024, v3
    s_cbranch_scc1 L_k4
L_mid:
    v_mov_b32 v3, v2
    ds_read_b128 v[24:27], v2
    buffer_load_dword v20, off, s[32:35], 0 sc1
    v_max_f32_dpp v10, v10, v10 quad_perm:[2,3,0,1] row_mask:0xf bank_mask:0xf
    s_nop 1
    v_max_f32_dpp v10, v10, v10 row_ror:4 row_mask:0xf bank_mask:0xf
    s_nop 1
    v_max_f32_dpp v10, v10, v10 row_ror:8 row_mask:0xf bank_mask:0xf
    v_mov_b32 v6, v10
    s_nop 1
    v_permlane16_swap_b32 v10, v6
    v_max_f32 v10, v10, v6
    v_mov_b32 v6, v10
    s_nop 1
    v_permlane32_swap_b32 v10, v6
    v_max_f32 v10, v10, v6
    v_mul_f32 v4, s50, v10
    v_fma_f32 v13, v13, s50, -v4
    v_exp_f32 v5, v13
    s_waitcnt lgkmcnt(0)
    v_fma_f32 v14, v24, s50, -v4
    v_exp_f32 v14, v14
    v_mov_b32_dpp v7, v5 quad_perm:[1,0,3,2] row_mask:0xf bank_mask:0xf
    v_cvt_pk_bf16_f32 v15, v5, v7
    v_mov_b32_dpp v6, v14 quad_perm:[1,0,3,2] row_mask:0xf bank_mask:0xf
    v_add_f32 v5, v5, v14
    v_mov_b32_dpp v16, v15 row_newbcast:0 row_mask:0xf bank_mask:0xf
    v_perm_b32 v48, v16, v16, v32
    v_perm_b32 v49, v16, v16, v33
    v_perm_b32 v50, v16, v16, v34
    v_perm_b32 v51, v16, v16, v35
    v_cvt_pk_bf16_f32 v15, v14, v6
    s_nop 0
    v_mfma_f32_16x16x32_bf16 v[28:31], v[48:51], v[60:63], 0
    v_mov_b32_dpp v16, v15 row_newbcast:0 row_mask:0xf bank_mask:0xf
    v_perm_b32 v44, v16, v16, v32
    v_perm_b32 v45, v16, v16, v33
    v_perm_b32 v46, v16, v16, v34
    v_perm_b32 v47, v16, v16, v35
    v_mov_b32_dpp v16, v15 row_newbcast:2 row_mask:0xf bank_mask:0xf
    v_perm_b32 v48, v16, v16, v32
    v_perm_b32 v49, v16, v16, v33
    v_perm_b32 v50, v16, v16, v34
    v_perm_b32 v51, v16, v16, v35
.p2align 3
L_v2:
    v_mfma_f32_16x16x32_bf16 v[28:31], v[44:47], v[68:71], v[28:31]
    s_waitcnt vmcnt(21)
    buffer_load_dwordx4 v[172:175], v1, s[24:27], s55 offen offset:2048 nt
    v_mov_b32_dpp v16, v15 row_newbcast:4 row_mask:0xf bank_mask:0xf
    v_fma_f32 v14, v25, s50, -v4
    v_perm_b32 v44, v16, v16, v32
    v_perm_b32 v45, v16, v16, v33
    v_perm_b32 v46, v16, v16, v34
    v_perm_b32 v47, v16, v16, v35
    v_mfma_f32_16x16x32_bf16 v[28:31], v[48:51], v[72:75], v[28:31]
    s_waitcnt vmcnt(21)
    buffer_load_dwordx4 v[176:179], v1, s[24:27], s55 offen offset:3072 nt
    v_mov_b32_dpp v16, v15 row_newbcast:6 row_mask:0xf bank_mask:0xf
    v_exp_f32 v14, v14
    v_perm_b32 v48, v16, v16, v32
    v_perm_b32 v49, v16, v16, v33
    v_perm_b32 v50, v16, v16, v34
    v_perm_b32 v51, v16, v16, v35
    v_mfma_f32_16x16x32_bf16 v[28:31], v[44:47], v[76:79], v[28:31]
    s_add_u32 s55, s54, s77
    s_and_b32 s55, s55, 0x1fffff
    s_waitcnt vmcnt(21)
    buffer_load_dwordx4 v[180:183], v1, s[24:27], s55 offen offset:0 nt
    v_mov_b32_dpp v16, v15 row_newbcast:8 row_mask:0xf bank_mask:0xf
    v_add_f32 v5, v5, v14
    v_perm_b32 v44, v16, v16, v32
    v_perm_b32 v45, v16, v16, v33
    v_perm_b32 v46, v16, v16, v34
    v_perm_b32 v47, v16, v16, v35
    v_mfma_f32_16x16x32_bf16 v[28:31], v[48:51], v[80:83], v[28:31]
    s_waitcnt vmcnt(21)
    buffer_load_dwordx4 v[184:187], v1, s[24:27], s55 offen offset:1024 nt
    v_mov_b32_dpp v16, v15 row_newbcast:10 row_mask:0xf bank_mask:0xf
    v_mov_b32_dpp v6, v14 quad_perm:[1,0,3,2] row_mask:0xf bank_mask:0xf
    v_perm_b32 v48, v16, v16, v32
    v_perm_b32 v49, v16, v16, v33
    v_perm_b32 v50, v16, v16, v34
    v_perm_b32 v51, v16, v16, v35
    v_mfma_f32_16x16x32_bf16 v[28:31], v[44:47], v[84:87], v[28:31]
    s_waitcnt vmcnt(21)
    buffer_load_dwordx4 v[188:191], v1, s[24:27], s55 offen offset:2048 nt
    v_mov_b32_dpp v16, v15 row_newbcast:12 row_mask:0xf bank_mask:0xf
    v_perm_b32 v44, v16, v16, v32
    v_perm_b32 v45, v16, v16, v33
    v_perm_b32 v46, v16, v16, v34
    v_perm_b32 v47, v16, v16, v35
    v_mfma_f32_16x16x32_bf16 v[28:31], v[48:51], v[88:91], v[28:31]
    s_waitcnt vmcnt(21)
    buffer_load_dwordx4 v[192:195], v1, s[24:27], s55 offen offset:3072 nt
    v_mov_b32_dpp v16, v15 row_newbcast:14 row_mask:0xf bank_mask:0xf
    v_cvt_pk_bf16_f32 v15, v14, v6
    v_perm_b32 v48, v16, v16, v32
    v_perm_b32 v49, v16, v16, v33
    v_perm_b32 v50, v16, v16, v34
    v_perm_b32 v51, v16, v16, v35
    v_mfma_f32_16x16x32_bf16 v[28:31], v[44:47], v[92:95], v[28:31]
    s_add_u32 s54, s54, 0x10000
    s_add_u32 s55, s54, s70
    s_and_b32 s55, s55, 0x1fffff
    s_waitcnt vmcnt(21)
    buffer_load_dwordx4 v[68:71], v1, s[24:27], s55 offen offset:0 nt
    v_mov_b32_dpp v16, v15 row_newbcast:0 row_mask:0xf bank_mask:0xf
    v_perm_b32 v44, v16, v16, v32
    v_perm_b32 v45, v16, v16, v33
    v_perm_b32 v46, v16, v16, v34
    v_perm_b32 v47, v16, v16, v35
    v_mfma_f32_16x16x32_bf16 v[28:31], v[48:51], v[96:99], v[28:31]
    s_waitcnt vmcnt(21)
    buffer_load_dwordx4 v[72:75], v1, s[24:27], s55 offen offset:1024 nt
    v_mov_b32_dpp v16, v15 row_newbcast:2 row_mask:0xf bank_mask:0xf
    v_perm_b32 v48, v16, v16, v32
    v_perm_b32 v49, v16, v16, v33
    v_perm_b32 v50, v16, v16, v34
    v_perm_b32 v51, v16, v16, v35
    v_mfma_f32_16x16x32_bf16 v[28:31], v[44:47], v[100:103], v[28:31]
    s_waitcnt vmcnt(21)
    buffer_load_dwordx4 v[76:79], v1, s[24:27], s55 offen offset:2048 nt
    v_mov_b32_dpp v16, v15 row_newbcast:4 row_mask:0xf bank_mask:0xf
    v_fma_f32 v14, v26, s50, -v4
    v_perm_b32 v44, v16, v16, v32
    v_perm_b32 v45, v16, v16, v33
    v_perm_b32 v46, v16, v16, v34
    v_perm_b32 v47, v16, v16, v35
    v_add_u32 v18, 1, v18
    buffer_store_short v18, v17, s[40:43], 0 offen
    v_mfma_f32_16x16x32_bf16 v[28:31], v[48:51], v[104:107], v[28:31]
    s_waitcnt vmcnt(21)
    buffer_load_dwordx4 v[80:83], v1, s[24:27], s55 offen offset:3072 nt
    v_mov_b32_dpp v16, v15 row_newbcast:6 row_mask:0xf bank_mask:0xf
    v_exp_f32 v14, v14
    v_perm_b32 v48, v16, v16, v32
    v_perm_b32 v49, v16, v16, v33
    v_perm_b32 v50, v16, v16, v34
    v_perm_b32 v51, v16, v16, v35
    v_mfma_f32_16x16x32_bf16 v[28:31], v[44:47], v[108:111], v[28:31]
    s_add_u32 s55, s54, s71
    s_and_b32 s55, s55, 0x1fffff
    s_waitcnt vmcnt(21)
    buffer_load_dwordx4 v[84:87], v1, s[24:27], s55 offen offset:0 nt
    v_mov_b32_dpp v16, v15 row_newbcast:8 row_mask:0xf bank_mask:0xf
    v_add_f32 v5, v5, v14
    v_perm_b32 v44, v16, v16, v32
    v_perm_b32 v45, v16, v16, v33
    v_perm_b32 v46, v16, v16, v34
    v_perm_b32 v47, v16, v16, v35
    v_mfma_f32_16x16x32_bf16 v[28:31], v[48:51], v[112:115], v[28:31]
    s_waitcnt vmcnt(21)
    buffer_load_dwordx4 v[88:91], v1, s[24:27], s55 offen offset:1024 nt
    v_mov_b32_dpp v16, v15 row_newbcast:10 row_mask:0xf bank_mask:0xf
    v_mov_b32_dpp v6, v14 quad_perm:[1,0,3,2] row_mask:0xf bank_mask:0xf
    v_perm_b32 v48, v16, v16, v32
    v_perm_b32 v49, v16, v16, v33
    v_perm_b32 v50, v16, v16, v34
    v_perm_b32 v51, v16, v16, v35
    s_lshl1_add_u32 s52, s51, -1
    s_max_i32 s52, s52, 0
    v_cmp_lt_u32 vcc, s52, v19
    s_and_b32 s60, vcc_lo, 0xffff
    s_bcnt1_i32_b32 s60, s60
    v_cmp_gt_u32 vcc, s52, v19
    s_and_b32 s61, vcc_lo, 0xffff
    s_bcnt1_i32_b32 s61, s61
    v_readlane_b32 s62, v19, s63
    v_mfma_f32_16x16x32_bf16 v[28:31], v[44:47], v[116:119], v[28:31]
    s_waitcnt vmcnt(21)
    buffer_load_dwordx4 v[92:95], v1, s[24:27], s55 offen offset:2048 nt
    v_mov_b32_dpp v16, v15 row_newbcast:12 row_mask:0xf bank_mask:0xf
    v_perm_b32 v44, v16, v16, v32
    v_perm_b32 v45, v16, v16, v33
    v_perm_b32 v46, v16, v16, v34
    v_perm_b32 v47, v16, v16, v35
    v_mfma_f32_16x16x32_bf16 v[28:31], v[48:51], v[120:123], v[28:31]
    s_waitcnt vmcnt(21)
    buffer_load_dwordx4 v[96:99], v1, s[24:27], s55 offen offset:3072 nt
    v_mov_b32_dpp v16, v15 row_newbcast:14 row_mask:0xf bank_mask:0xf
    v_cvt_pk_bf16_f32 v15, v14, v6
    v_perm_b32 v48, v16, v16, v32
    v_perm_b32 v49, v16, v16, v33
    v_perm_b32 v50, v16, v16, v34
    v_perm_b32 v51, v16, v16, v35
    s_sext_i32_i16 s53, s62
    s_sub_i32 s60, s60, s61
    s_add_i32 s60, s60, s53
    s_cmp_gt_i32 s60, -4
    s_cselect_b32 s67, 1, 0
    s_cmp_gt_i32 s60, -1
    s_cselect_b32 s67, 2, s67
    s_cmp_gt_i32 s60, 2
    s_cselect_b32 s67, 3, s67
    s_cmp_gt_i32 s60, 5
    s_cselect_b32 s67, 4, s67
    v_mfma_f32_16x16x32_bf16 v[28:31], v[44:47], v[124:127], v[28:31]
    s_add_u32 s55, s54, s72
    s_and_b32 s55, s55, 0x1fffff
    s_waitcnt vmcnt(21)
    buffer_load_dwordx4 v[100:103], v1, s[24:27], s55 offen offset:0 nt
    v_mov_b32_dpp v16, v15 row_newbcast:0 row_mask:0xf bank_mask:0xf
    v_perm_b32 v44, v16, v16, v32
    v_perm_b32 v45, v16, v16, v33
    v_perm_b32 v46, v16, v16, v34
    v_perm_b32 v47, v16, v16, v35
    s_cmp_lg_u32 s67, 2
    s_cbranch_scc1 L_v_pick
L_v2_u:
    v_mfma_f32_16x16x32_bf16 v[28:31], v[48:51], v[128:131], v[28:31]
    s_waitcnt vmcnt(21)
    buffer_load_dwordx4 v[104:107], v1, s[24:27], s55 offen offset:1024 nt
    v_mov_b32_dpp v16, v15 row_newbcast:2 row_mask:0xf bank_mask:0xf
    v_perm_b32 v48, v16, v16, v32
    v_perm_b32 v49, v16, v16, v33
    v_perm_b32 v50, v16, v16, v34
    v_perm_b32 v51, v16, v16, v35
    v_mfma_f32_16x16x32_bf16 v[28:31], v[44:47], v[132:135], v[28:31]
    s_waitcnt vmcnt(21)
    buffer_load_dwordx4 v[108:111], v1, s[24:27], s55 offen offset:2048 nt
    v_mov_b32_dpp v16, v15 row_newbcast:4 row_mask:0xf bank_mask:0xf
    v_fma_f32 v14, v27, s50, -v4
    v_perm_b32 v44, v16, v16, v32
    v_perm_b32 v45, v16, v16, v33
    v_perm_b32 v46, v16, v16, v34
    v_perm_b32 v47, v16, v16, v35
    buffer_load_ushort v19, v17, s[36:39], 0 offen sc1
    v_mfma_f32_16x16x32_bf16 v[28:31], v[48:51], v[136:139], v[28:31]
    s_waitcnt vmcnt(21)
    buffer_load_dwordx4 v[112:115], v1, s[24:27], s55 offen offset:3072 nt
    v_mov_b32_dpp v16, v15 row_newbcast:6 row_mask:0xf bank_mask:0xf
    ds_read_b128 v[24:27], v3 offset:1024
    v_exp_f32 v14, v14
    v_perm_b32 v48, v16, v16, v32
    v_perm_b32 v49, v16, v16, v33
    v_perm_b32 v50, v16, v16, v34
    v_perm_b32 v51, v16, v16, v35
    v_mfma_f32_16x16x32_bf16 v[28:31], v[44:47], v[140:143], v[28:31]
    s_add_u32 s55, s54, s73
    s_and_b32 s55, s55, 0x1fffff
    s_waitcnt vmcnt(21)
    buffer_load_dwordx4 v[116:119], v1, s[24:27], s55 offen offset:0 nt
    v_mov_b32_dpp v16, v15 row_newbcast:8 row_mask:0xf bank_mask:0xf
    v_add_f32 v5, v5, v14
    v_perm_b32 v44, v16, v16, v32
    v_perm_b32 v45, v16, v16, v33
    v_perm_b32 v46, v16, v16, v34
    v_perm_b32 v47, v16, v16, v35
    v_mfma_f32_16x16x32_bf16 v[28:31], v[48:51], v[144:147], v[28:31]
    s_waitcnt vmcnt(21)
    buffer_load_dwordx4 v[120:123], v1, s[24:27], s55 offen offset:1024 nt
    v_mov_b32_dpp v16, v15 row_newbcast:10 row_mask:0xf bank_mask:0xf
    v_mov_b32_dpp v6, v14 quad_perm:[1,0,3,2] row_mask:0xf bank_mask:0xf
    v_perm_b32 v48, v16, v16, v32
    v_perm_b32 v49, v16, v16, v33
    v_perm_b32 v50, v16, v16, v34
    v_perm_b32 v51, v16, v16, v35
    v_mfma_f32_16x16x32_bf16 v[28:31], v[44:47], v[148:151], v[28:31]
    s_waitcnt vmcnt(21)
    buffer_load_dwordx4 v[124:127], v1, s[24:27], s55 offen offset:2048 nt
    v_mov_b32_dpp v16, v15 row_newbcast:12 row_mask:0xf bank_mask:0xf
    v_perm_b32 v44, v16, v16, v32
    v_perm_b32 v45, v16, v16, v33
    v_perm_b32 v46, v16, v16, v34
    v_perm_b32 v47, v16, v16, v35
    v_mfma_f32_16x16x32_bf16 v[28:31], v[48:51], v[152:155], v[28:31]
    s_waitcnt vmcnt(21)
    buffer_load_dwordx4 v[128:131], v1, s[24:27], s55 offen offset:3072 nt
    v_mov_b32_dpp v16, v15 row_newbcast:14 row_mask:0xf bank_mask:0xf
    v_cvt_pk_bf16_f32 v15, v14, v6
    v_perm_b32 v48, v16, v16, v32
    v_perm_b32 v49, v16, v16, v33
    v_perm_b32 v50, v16, v16, v34
    v_perm_b32 v51, v16, v16, v35
    v_mfma_f32_16x16x32_bf16 v[28:31], v[44:47], v[156:159], v[28:31]
    s_add_u32 s55, s54, s74
    s_and_b32 s55, s55, 0x1fffff
    s_waitcnt vmcnt(21)
    buffer_load_dwordx4 v[132:135], v1, s[24:27], s55 offen offset:0 nt
    v_mov_b32_dpp v16, v15 row_newbcast:0 row_mask:0xf bank_mask:0xf
    v_perm_b32 v44, v16, v16, v32
    v_perm_b32 v45, v16, v16, v33
    v_perm_b32 v46, v16, v16, v34
    v_perm_b32 v47, v16, v16, v35
    v_add_u32 v18, 1, v18
    buffer_store_short v18, v17, s[40:43], 0 offen
    v_mfma_f32_16x16x32_bf16 v[28:31], v[48:51], v[160:163], v[28:31]
    s_waitcnt vmcnt(21)
    buffer_load_dwordx4 v[136:139], v1, s[24:27], s55 offen offset:1024 nt
    v_mov_b32_dpp v16, v15 row_newbcast:2 row_mask:0xf bank_mask:0xf
    v_perm_b32 v48, v16, v16, v32
    v_perm_b32 v49, v16, v16, v33
    v_perm_b32 v50, v16, v16, v34
    v_perm_b32 v51, v16, v16, v35
    v_mfma_f32_16x16x32_bf16 v[28:31], v[44:47], v[164:167], v[28:31]
    s_waitcnt vmcnt(21)
    buffer_load_dwordx4 v[140:143], v1, s[24:27], s55 offen offset:2048 nt
    v_mov_b32_dpp v16, v15 row_newbcast:4 row_mask:0xf bank_mask:0xf
    s_waitcnt lgkmcnt(0)
    v_fma_f32 v14, v24, s50, -v4
    v_perm_b32 v44, v16, v16, v32
    v_perm_b32 v45, v16, v16, v33
    v_perm_b32 v46, v16, v16, v34
    v_perm_b32 v47, v16, v16, v35
    v_mfma_f32_16x16x32_bf16 v[28:31], v[48:51], v[168:171], v[28:31]
    s_waitcnt vmcnt(21)
    buffer_load_dwordx4 v[144:147], v1, s[24:27], s55 offen offset:3072 nt
    v_mov_b32_dpp v16, v15 row_newbcast:6 row_mask:0xf bank_mask:0xf
    v_exp_f32 v14, v14
    v_perm_b32 v48, v16, v16, v32
    v_perm_b32 v49, v16, v16, v33
    v_perm_b32 v50, v16, v16, v34
    v_perm_b32 v51, v16, v16, v35
    s_sub_u32 s52, s51, s64
    s_cmp_lt_u32 s52, 3
    s_cbranch_scc1 L_v2_round
L_v2_t:
    v_mfma_f32_16x16x32_bf16 v[28:31], v[44:47], v[172:175], v[28:31]
    s_add_u32 s55, s54, s75
    s_and_b32 s55, s55, 0x1fffff
    s_waitcnt vmcnt(21)
    buffer_load_dwordx4 v[148:151], v1, s[24:27], s55 offen offset:0 nt
    v_mov_b32_dpp v16, v15 row_newbcast:8 row_mask:0xf bank_mask:0xf
    v_add_f32 v5, v5, v14
    v_perm_b32 v44, v16, v16, v32
    v_perm_b32 v45, v16, v16, v33
    v_perm_b32 v46, v16, v16, v34
    v_perm_b32 v47, v16, v16, v35
    v_mfma_f32_16x16x32_bf16 v[28:31], v[48:51], v[176:179], v[28:31]
    s_waitcnt vmcnt(21)
    buffer_load_dwordx4 v[152:155], v1, s[24:27], s55 offen offset:1024 nt
    v_mov_b32_dpp v16, v15 row_newbcast:10 row_mask:0xf bank_mask:0xf
    v_mov_b32_dpp v6, v14 quad_perm:[1,0,3,2] row_mask:0xf bank_mask:0xf
    v_perm_b32 v48, v16, v16, v32
    v_perm_b32 v49, v16, v16, v33
    v_perm_b32 v50, v16, v16, v34
    v_perm_b32 v51, v16, v16, v35
    v_mfma_f32_16x16x32_bf16 v[28:31], v[44:47], v[180:183], v[28:31]
    s_waitcnt vmcnt(21)
    buffer_load_dwordx4 v[156:159], v1, s[24:27], s55 offen offset:2048 nt
    v_mov_b32_dpp v16, v15 row_newbcast:12 row_mask:0xf bank_mask:0xf
    v_perm_b32 v44, v16, v16, v32
    v_perm_b32 v45, v16, v16, v33
    v_perm_b32 v46, v16, v16, v34
    v_perm_b32 v47, v16, v16, v35
    v_mfma_f32_16x16x32_bf16 v[28:31], v[48:51], v[184:187], v[28:31]
    s_waitcnt vmcnt(21)
    buffer_load_dwordx4 v[160:163], v1, s[24:27], s55 offen offset:3072 nt
    v_mov_b32_dpp v16, v15 row_newbcast:14 row_mask:0xf bank_mask:0xf
    v_cvt_pk_bf16_f32 v15, v14, v6
    v_perm_b32 v48, v16, v16, v32
    v_perm_b32 v49, v16, v16, v33
    v_perm_b32 v50, v16, v16, v34
    v_perm_b32 v51, v16, v16, v35
    v_mfma_f32_16x16x32_bf16 v[28:31], v[44:47], v[188:191], v[28:31]
    s_add_u32 s55, s54, s76
    s_and_b32 s55, s55, 0x1fffff
    s_waitcnt vmcnt(21)
    buffer_load_dwordx4 v[164:167], v1, s[24:27], s55 offen offset:0 nt
    v_mov_b32_dpp v16, v15 row_newbcast:0 row_mask:0xf bank_mask:0xf
    v_perm_b32 v44, v16, v16, v32
    v_perm_b32 v45, v16, v16, v33
    v_perm_b32 v46, v16, v16, v34
    v_perm_b32 v47, v16, v16, v35
    v_mfma_f32_16x16x32_bf16 v[28:31], v[48:51], v[192:195], v[28:31]
    s_waitcnt vmcnt(21)
    buffer_load_dwordx4 v[168:171], v1, s[24:27], s55 offen offset:1024 nt
    v_mov_b32_dpp v16, v15 row_newbcast:2 row_mask:0xf bank_mask:0xf
    v_perm_b32 v48, v16, v16, v32
    v_perm_b32 v49, v16, v16, v33
    v_perm_b32 v50, v16, v16, v34
    v_perm_b32 v51, v16, v16, v35
    s_cmp_eq_u32 s51, 62
    s_cbranch_scc1 L_last
    s_add_u32 s51, s51, 1
    v_add_u32 v3, 1024, v3
    s_branch L_v2
.p2align 6
L_v0:
    v_mfma_f32_16x16x32_bf16 v[28:31], v[44:47], v[68:71], v[28:31]
    s_waitcnt vmcnt(19)
    buffer_load_dwordx4 v[172:175], v1, s[24:27], s55 offen offset:2048 nt
    v_mov_b32_dpp v16, v15 row_newbcast:4 row_mask:0xf bank_mask:0xf
    v_fma_f32 v14, v25, s50, -v4
    v_perm_b32 v44, v16, v16, v32
    v_perm_b32 v45, v16, v16, v33
    v_perm_b32 v46, v16, v16, v34
    v_perm_b32 v47, v16, v16, v35
    v_mfma_f32_16x16x32_bf16 v[28:31], v[48:51], v[72:75], v[28:31]
    s_waitcnt vmcnt(19)
    buffer_load_dwordx4 v[176:179], v1, s[24:27], s55 offen offset:3072 nt
    v_mov_b32_dpp v16, v15 row_newbcast:6 row_mask:0xf bank_mask:0xf
    v_exp_f32 v14, v14
    v_perm_b32 v48, v16, v16, v32
    v_perm_b32 v49, v16, v16, v33
    v_perm_b32 v50, v16, v16, v34
    v_perm_b32 v51, v16, v16, v35
    v_mfma_f32_16x16x32_bf16 v[28:31], v[44:47], v[76:79], v[28:31]
    s_add_u32 s55, s54, s77
    s_and_b32 s55, s55, 0x1fffff
    s_waitcnt vmcnt(19)
    buffer_load_dwordx4 v[180:183], v1, s[24:27], s55 offen offset:0 nt
    v_mov_b32_dpp v16, v15 row_newbcast:8 row_mask:0xf bank_mask:0xf
    v_add_f32 v5, v5, v14
    v_perm_b32 v44, v16, v16, v32
    v_perm_b32 v45, v16, v16, v33
    v_perm_b32 v46, v16, v16, v34
    v_perm_b32 v47, v16, v16, v35
    v_mfma_f32_16x16x32_bf16 v[28:31], v[48:51], v[80:83], v[28:31]
    s_waitcnt vmcnt(19)
    buffer_load_dwordx4 v[184:187], v1, s[24:27], s55 offen offset:1024 nt
    v_mov_b32_dpp v16, v15 row_newbcast:10 row_mask:0xf bank_mask:0xf
    v_mov_b32_dpp v6, v14 quad_perm:[1,0,3,2] row_mask:0xf bank_mask:0xf
    v_perm_b32 v48, v16, v16, v32
    v_perm_b32 v49, v16, v16, v33
    v_perm_b32 v50, v16, v16, v34
    v_perm_b32 v51, v16, v16, v35
    v_mfma_f32_16x16x32_bf16 v[28:31], v[44:47], v[84:87], v[28:31]
    s_waitcnt vmcnt(19)
    buffer_load_dwordx4 v[188:191], v1, s[24:27], s55 offen offset:2048 nt
    v_mov_b32_dpp v16, v15 row_newbcast:12 row_mask:0xf bank_mask:0xf
    v_perm_b32 v44, v16, v16, v32
    v_perm_b32 v45, v16, v16, v33
    v_perm_b32 v46, v16, v16, v34
    v_perm_b32 v47, v16, v16, v35
    v_mfma_f32_16x16x32_bf16 v[28:31], v[48:51], v[88:91], v[28:31]
    s_waitcnt vmcnt(19)
    buffer_load_dwordx4 v[192:195], v1, s[24:27], s55 offen offset:3072 nt
    v_mov_b32_dpp v16, v15 row_newbcast:14 row_mask:0xf bank_mask:0xf
    v_cvt_pk_bf16_f32 v15, v14, v6
    v_perm_b32 v48, v16, v16, v32
    v_perm_b32 v49, v16, v16, v33
    v_perm_b32 v50, v16, v16, v34
    v_perm_b32 v51, v16, v16, v35
    v_mfma_f32_16x16x32_bf16 v[28:31], v[44:47], v[92:95], v[28:31]
    s_add_u32 s54, s54, 0x10000
    s_add_u32 s55, s54, s70
    s_and_b32 s55, s55, 0x1fffff
    s_waitcnt vmcnt(19)
    buffer_load_dwordx4 v[68:71], v1, s[24:27], s55 offen offset:0 nt
    v_mov_b32_dpp v16, v15 row_newbcast:0 row_mask:0xf bank_mask:0xf
    v_perm_b32 v44, v16, v16, v32
    v_perm_b32 v45, v16, v16, v33
    v_perm_b32 v46, v16, v16, v34
    v_perm_b32 v47, v16, v16, v35
    v_mfma_f32_16x16x32_bf16 v[28:31], v[48:51], v[96:99], v[28:31]
    s_waitcnt vmcnt(19)
    buffer_load_dwordx4 v[72:75], v1, s[24:27], s55 offen offset:1024 nt
    v_mov_b32_dpp v16, v15 row_newbcast:2 row_mask:0xf bank_mask:0xf
    v_perm_b32 v48, v16, v16, v32
    v_perm_b32 v49, v16, v16, v33
    v_perm_b32 v50, v16, v16, v34
    v_perm_b32 v51, v16, v16, v35
    v_mfma_f32_16x16x32_bf16 v[28:31], v[44:47], v[100:103], v[28:31]
    s_waitcnt vmcnt(19)
    buffer_load_dwordx4 v[76:79], v1, s[24:27], s55 offen offset:2048 nt
    v_mov_b32_dpp v16, v15 row_newbcast:4 row_mask:0xf bank_mask:0xf
    v_fma_f32 v14, v26, s50, -v4
    v_perm_b32 v44, v16, v16, v32
    v_perm_b32 v45, v16, v16, v33
    v_perm_b32 v46, v16, v16, v34
    v_perm_b32 v47, v16, v16, v35
    v_add_u32 v18, 1, v18
    buffer_store_short v18, v17, s[40:43], 0 offen
    v_mfma_f32_16x16x32_bf16 v[28:31], v[48:51], v[104:107], v[28:31]
    s_waitcnt vmcnt(19)
    buffer_load_dwordx4 v[80:83], v1, s[24:27], s55 offen offset:3072 nt
    v_mov_b32_dpp v16, v15 row_newbcast:6 row_mask:0xf bank_mask:0xf
    v_exp_f32 v14, v14
    v_perm_b32 v48, v16, v16, v32
    v_perm_b32 v49, v16, v16, v33
    v_perm_b32 v50, v16, v16, v34
    v_perm_b32 v51, v16, v16, v35
    v_mfma_f32_16x16x32_bf16 v[28:31], v[44:47], v[108:111], v[28:31]
    s_add_u32 s55, s54, s71
    s_and_b32 s55, s55, 0x1fffff
    s_waitcnt vmcnt(19)
    buffer_load_dwordx4 v[84:87], v1, s[24:27], s55 offen offset:0 nt
    v_mov_b32_dpp v16, v15 row_newbcast:8 row_mask:0xf bank_mask:0xf
    v_add_f32 v5, v5, v14
    v_perm_b32 v44, v16, v16, v32
    v_perm_b32 v45, v16, v16, v33
    v_perm_b32 v46, v16, v16, v34
    v_perm_b32 v47, v16, v16, v35
    v_mfma_f32_16x16x32_bf16 v[28:31], v[48:51], v[112:115], v[28:31]
    s_waitcnt vmcnt(19)
    buffer_load_dwordx4 v[88:91], v1, s[24:27], s55 offen offset:1024 nt
    v_mov_b32_dpp v16, v15 row_newbcast:10 row_mask:0xf bank_mask:0xf
    v_mov_b32_dpp v6, v14 quad_perm:[1,0,3,2] row_mask:0xf bank_mask:0xf
    v_perm_b32 v48, v16, v16, v32
    v_perm_b32 v49, v16, v16, v33
    v_perm_b32 v50, v16, v16, v34
    v_perm_b32 v51, v16, v16, v35
    s_lshl1_add_u32 s52, s51, -1
    s_max_i32 s52, s52, 0
    v_cmp_lt_u32 vcc, s52, v19
    s_and_b32 s60, vcc_lo, 0xffff
    s_bcnt1_i32_b32 s60, s60
    v_cmp_gt_u32 vcc, s52, v19
    s_and_b32 s61, vcc_lo, 0xffff
    s_bcnt1_i32_b32 s61, s61
    v_readlane_b32 s62, v19, s63
    v_mfma_f32_16x16x32_bf16 v[28:31], v[44:47], v[116:119], v[28:31]
    s_waitcnt vmcnt(19)
    buffer_load_dwordx4 v[92:95], v1, s[24:27], s55 offen offset:2048 nt
    v_mov_b32_dpp v16, v15 row_newbcast:12 row_mask:0xf bank_mask:0xf
    v_perm_b32 v44, v16, v16, v32
    v_perm_b32 v45, v16, v16, v33
    v_perm_b32 v46, v16, v16, v34
    v_perm_b32 v47, v16, v16, v35
    v_mfma_f32_16x16x32_bf16 v[28:31], v[48:51], v[120:123], v[28:31]
    s_waitcnt vmcnt(19)
    buffer_load_dwordx4 v[96:99], v1, s[24:27], s55 offen offset:3072 nt
    v_mov_b32_dpp v16, v15 row_newbcast:14 row_mask:0xf bank_mask:0xf
    v_cvt_pk_bf16_f32 v15, v14, v6
    v_perm_b32 v48, v16, v16, v32
    v_perm_b32 v49, v16, v16, v33
    v_perm_b32 v50, v16, v16, v34
    v_perm_b32 v51, v16, v16, v35
    s_sext_i32_i16 s53, s62
    s_sub_i32 s60, s60, s61
    s_add_i32 s60, s60, s53
    s_cmp_gt_i32 s60, -4
    s_cselect_b32 s67, 1, 0
    s_cmp_gt_i32 s60, -1
    s_cselect_b32 s67, 2, s67
    s_cmp_gt_i32 s60, 2
    s_cselect_b32 s67, 3, s67
    s_cmp_gt_i32 s60, 5
    s_cselect_b32 s67, 4, s67
    v_mfma_f32_16x16x32_bf16 v[28:31], v[44:47], v[124:127], v[28:31]
    s_add_u32 s55, s54, s72
    s_and_b32 s55, s55, 0x1fffff
    s_waitcnt vmcnt(19)
    buffer_load_dwordx4 v[100:103], v1, s[24:27], s55 offen offset:0 nt
    v_mov_b32_dpp v16, v15 row_newbcast:0 row_mask:0xf bank_mask:0xf
    v_perm_b32 v44, v16, v16, v32
    v_perm_b32 v45, v16, v16, v33
    v_perm_b32 v46, v16, v16, v34
    v_perm_b32 v47, v16, v16, v35
    s_cmp_lg_u32 s67, 0
    s_cbranch_scc1 L_v_pick
L_v0_u:
    v_mfma_f32_16x16x32_bf16 v[28:31], v[48:51], v[128:131], v[28:31]
    s_waitcnt vmcnt(19)
    buffer_load_dwordx4 v[104:107], v1, s[24:27], s55 offen offset:1024 nt
    v_mov_b32_dpp v16, v15 row_newbcast:2 row_mask:0xf bank_mask:0xf
    v_perm_b32 v48, v16, v16, v32
    v_perm_b32 v49, v16, v16, v33
    v_perm_b32 v50, v16, v16, v34
    v_perm_b32 v51, v16, v16, v35
    v_mfma_f32_16x16x32_bf16 v[28:31], v[44:47], v[132:135], v[28:31]
    s_waitcnt vmcnt(19)
    buffer_load_dwordx4 v[108:111], v1, s[24:27], s55 offen offset:2048 nt
    v_mov_b32_dpp v16, v15 row_newbcast:4 row_mask:0xf bank_mask:0xf
    v_fma_f32 v14, v27, s50, -v4
    v_perm_b32 v44, v16, v16, v32
    v_perm_b32 v45, v16, v16, v33
    v_perm_b32 v46, v16, v16, v34
    v_perm_b32 v47, v16, v16, v35
    buffer_load_ushort v19, v17, s[36:39], 0 offen sc1
    v_mfma_f32_16x16x32_bf16 v[28:31], v[48:51], v[136:139], v[28:31]
    s_waitcnt vmcnt(19)
    buffer_load_dwordx4 v[112:115], v1, s[24:27], s55 offen offset:3072 nt
    v_mov_b32_dpp v16, v15 row_newbcast:6 row_mask:0xf bank_mask:0xf
    ds_read_b128 v[24:27], v3 offset:1024
    v_exp_f32 v14, v14
    v_perm_b32 v48, v16, v16, v32
    v_perm_b32 v49, v16, v16, v33
    v_perm_b32 v50, v16, v16, v34
    v_perm_b32 v51, v16, v16, v35
    v_mfma_f32_16x16x32_bf16 v[28:31], v[44:47], v[140:143], v[28:31]
    s_add_u32 s55, s54, s73
    s_and_b32 s55, s55, 0x1fffff
    s_waitcnt vmcnt(19)
    buffer_load_dwordx4 v[116:119], v1, s[24:27], s55 offen offset:0 nt
    v_mov_b32_dpp v16, v15 row_newbcast:8 row_mask:0xf bank_mask:0xf
    v_add_f32 v5, v5, v14
    v_perm_b32 v44, v16, v16, v32
    v_perm_b32 v45, v16, v16, v33
    v_perm_b32 v46, v16, v16, v34
    v_perm_b32 v47, v16, v16, v35
    v_mfma_f32_16x16x32_bf16 v[28:31], v[48:51], v[144:147], v[28:31]
    s_waitcnt vmcnt(19)
    buffer_load_dwordx4 v[120:123], v1, s[24:27], s55 offen offset:1024 nt
    v_mov_b32_dpp v16, v15 row_newbcast:10 row_mask:0xf bank_mask:0xf
    v_mov_b32_dpp v6, v14 quad_perm:[1,0,3,2] row_mask:0xf bank_mask:0xf
    v_perm_b32 v48, v16, v16, v32
    v_perm_b32 v49, v16, v16, v33
    v_perm_b32 v50, v16, v16, v34
    v_perm_b32 v51, v16, v16, v35
    v_mfma_f32_16x16x32_bf16 v[28:31], v[44:47], v[148:151], v[28:31]
    s_waitcnt vmcnt(19)
    buffer_load_dwordx4 v[124:127], v1, s[24:27], s55 offen offset:2048 nt
    v_mov_b32_dpp v16, v15 row_newbcast:12 row_mask:0xf bank_mask:0xf
    v_perm_b32 v44, v16, v16, v32
    v_perm_b32 v45, v16, v16, v33
    v_perm_b32 v46, v16, v16, v34
    v_perm_b32 v47, v16, v16, v35
    v_mfma_f32_16x16x32_bf16 v[28:31], v[48:51], v[152:155], v[28:31]
    s_waitcnt vmcnt(19)
    buffer_load_dwordx4 v[128:131], v1, s[24:27], s55 offen offset:3072 nt
    v_mov_b32_dpp v16, v15 row_newbcast:14 row_mask:0xf bank_mask:0xf
    v_cvt_pk_bf16_f32 v15, v14, v6
    v_perm_b32 v48, v16, v16, v32
    v_perm_b32 v49, v16, v16, v33
    v_perm_b32 v50, v16, v16, v34
    v_perm_b32 v51, v16, v16, v35
    v_mfma_f32_16x16x32_bf16 v[28:31], v[44:47], v[156:159], v[28:31]
    s_add_u32 s55, s54, s74
    s_and_b32 s55, s55, 0x1fffff
    s_waitcnt vmcnt(19)
    buffer_load_dwordx4 v[132:135], v1, s[24:27], s55 offen offset:0 nt
    v_mov_b32_dpp v16, v15 row_newbcast:0 row_mask:0xf bank_mask:0xf
    v_perm_b32 v44, v16, v16, v32
    v_perm_b32 v45, v16, v16, v33
    v_perm_b32 v46, v16, v16, v34
    v_perm_b32 v47, v16, v16, v35
    v_add_u32 v18, 1, v18
    buffer_store_short v18, v17, s[40:43], 0 offen
    v_mfma_f32_16x16x32_bf16 v[28:31], v[48:51], v[160:163], v[28:31]
    s_waitcnt vmcnt(19)
    buffer_load_dwordx4 v[136:139], v1, s[24:27], s55 offen offset:1024 nt
    v_mov_b32_dpp v16, v15 row_newbcast:2 row_mask:0xf bank_mask:0xf
    v_perm_b32 v48, v16, v16, v32
    v_perm_b32 v49, v16, v16, v33
    v_perm_b32 v50, v16, v16, v34
    v_perm_b32 v51, v16, v16, v35
    v_mfma_f32_16x16x32_bf16 v[28:31], v[44:47], v[164:167], v[28:31]
    s_waitcnt vmcnt(19)
    buffer_load_dwordx4 v[140:143], v1, s[24:27], s55 offen offset:2048 nt
    v_mov_b32_dpp v16, v15 row_newbcast:4 row_mask:0xf bank_mask:0xf
    s_waitcnt lgkmcnt(0)
    v_fma_f32 v14, v24, s50, -v4
    v_perm_b32 v44, v16, v16, v32
    v_perm_b32 v45, v16, v16, v33
    v_perm_b32 v46, v16, v16, v34
    v_perm_b32 v47, v16, v16, v35
    v_mfma_f32_16x16x32_bf16 v[28:31], v[48:51], v[168:171], v[28:31]
    s_waitcnt vmcnt(19)
    buffer_load_dwordx4 v[144:147], v1, s[24:27], s55 offen offset:3072 nt
    v_mov_b32_dpp v16, v15 row_newbcast:6 row_mask:0xf bank_mask:0xf
    v_exp_f32 v14, v14
    v_perm_b32 v48, v16, v16, v32
    v_perm_b32 v49, v16, v16, v33
    v_perm_b32 v50, v16, v16, v34
    v_perm_b32 v51, v16, v16, v35
    s_sub_u32 s52, s51, s64
    s_cmp_lt_u32 s52, 3
    s_cbranch_scc1 L_v0_round
L_v0_t:
    v_mfma_f32_16x16x32_bf16 v[28:31], v[44:47], v[172:175], v[28:31]
    s_add_u32 s55, s54, s75
    s_and_b32 s55, s55, 0x1fffff
    s_waitcnt vmcnt(19)
    buffer_load_dwordx4 v[148:151], v1, s[24:27], s55 offen offset:0 nt
    v_mov_b32_dpp v16, v15 row_newbcast:8 row_mask:0xf bank_mask:0xf
    v_add_f32 v5, v5, v14
    v_perm_b32 v44, v16, v16, v32
    v_perm_b32 v45, v16, v16, v33
    v_perm_b32 v46, v16, v16, v34
    v_perm_b32 v47, v16, v16, v35
    v_mfma_f32_16x16x32_bf16 v[28:31], v[48:51], v[176:179], v[28:31]
    s_waitcnt vmcnt(19)
    buffer_load_dwordx4 v[152:155], v1, s[24:27], s55 offen offset:1024 nt
    v_mov_b32_dpp v16, v15 row_newbcast:10 row_mask:0xf bank_mask:0xf
    v_mov_b32_dpp v6, v14 quad_perm:[1,0,3,2] row_mask:0xf bank_mask:0xf
    v_perm_b32 v48, v16, v16, v32
    v_perm_b32 v49, v16, v16, v33
    v_perm_b32 v50, v16, v16, v34
    v_perm_b32 v51, v16, v16, v35
    v_mfma_f32_16x16x32_bf16 v[28:31], v[44:47], v[180:183], v[28:31]
    s_waitcnt vmcnt(19)
    buffer_load_dwordx4 v[156:159], v1, s[24:27], s55 offen offset:2048 nt
    v_mov_b32_dpp v16, v15 row_newbcast:12 row_mask:0xf bank_mask:0xf
    v_perm_b32 v44, v16, v16, v32
    v_perm_b32 v45, v16, v16, v33
    v_perm_b32 v46, v16, v16, v34
    v_perm_b32 v47, v16, v16, v35
    v_mfma_f32_16x16x32_bf16 v[28:31], v[48:51], v[184:187], v[28:31]
    s_waitcnt vmcnt(19)
    buffer_load_dwordx4 v[160:163], v1, s[24:27], s55 offen offset:3072 nt
    v_mov_b32_dpp v16, v15 row_newbcast:14 row_mask:0xf bank_mask:0xf
    v_cvt_pk_bf16_f32 v15, v14, v6
    v_perm_b32 v48, v16, v16, v32
    v_perm_b32 v49, v16, v16, v33
    v_perm_b32 v50, v16, v16, v34
    v_perm_b32 v51, v16, v16, v35
    v_mfma_f32_16x16x32_bf16 v[28:31], v[44:47], v[188:191], v[28:31]
    s_add_u32 s55, s54, s76
    s_and_b32 s55, s55, 0x1fffff
    s_waitcnt vmcnt(19)
    buffer_load_dwordx4 v[164:167], v1, s[24:27], s55 offen offset:0 nt
    v_mov_b32_dpp v16, v15 row_newbcast:0 row_mask:0xf bank_mask:0xf
    v_perm_b32 v44, v16, v16, v32
    v_perm_b32 v45, v16, v16, v33
    v_perm_b32 v46, v16, v16, v34
    v_perm_b32 v47, v16, v16, v35
    v_mfma_f32_16x16x32_bf16 v[28:31], v[48:51], v[192:195], v[28:31]
    s_waitcnt vmcnt(19)
    buffer_load_dwordx4 v[168:171], v1, s[24:27], s55 offen offset:1024 nt
    v_mov_b32_dpp v16, v15 row_newbcast:2 row_mask:0xf bank_mask:0xf
    v_perm_b32 v48, v16, v16, v32
    v_perm_b32 v49, v16, v16, v33
    v_perm_b32 v50, v16, v16, v34
    v_perm_b32 v51, v16, v16, v35
    s_cmp_eq_u32 s51, 62
    s_cbranch_scc1 L_last
    s_add_u32 s51, s51, 1
    v_add_u32 v3, 1024, v3
    s_branch L_v0
.p2align 6
L_v1:
    v_mfma_f32_16x16x32_bf16 v[28:31], v[44:47], v[68:71], v[28:31]
    s_waitcnt vmcnt(20)
    buffer_load_dwordx4 v[172:175], v1, s[24:27], s55 offen offset:2048 nt
    v_mov_b32_dpp v16, v15 row_newbcast:4 row_mask:0xf bank_mask:0xf
    v_fma_f32 v14, v25, s50, -v4
    v_perm_b32 v44, v16, v16, v32
    v_perm_b32 v45, v16, v16, v33
    v_perm_b32 v46, v16, v16, v34
    v_perm_b32 v47, v16, v16, v35
    v_mfma_f32_16x16x32_bf16 v[28:31], v[48:51], v[72:75], v[28:31]
    s_waitcnt vmcnt(20)
    buffer_load_dwordx4 v[176:179], v1, s[24:27], s55 offen offset:3072 nt
    v_mov_b32_dpp v16, v15 row_newbcast:6 row_mask:0xf bank_mask:0xf
    v_exp_f32 v14, v14
    v_perm_b32 v48, v16, v16, v32
    v_perm_b32 v49, v16, v16, v33
    v_perm_b32 v50, v16, v16, v34
    v_perm_b32 v51, v16, v16, v35
    v_mfma_f32_16x16x32_bf16 v[28:31], v[44:47], v[76:79], v[28:31]
    s_add_u32 s55, s54, s77
    s_and_b32 s55, s55, 0x1fffff
    s_waitcnt vmcnt(20)
    buffer_load_dwordx4 v[180:183], v1, s[24:27], s55 offen offset:0 nt
    v_mov_b32_dpp v16, v15 row_newbcast:8 row_mask:0xf bank_mask:0xf
    v_add_f32 v5, v5, v14
    v_perm_b32 v44, v16, v16, v32
    v_perm_b32 v45, v16, v16, v33
    v_perm_b32 v46, v16, v16, v34
    v_perm_b32 v47, v16, v16, v35
    v_mfma_f32_16x16x32_bf16 v[28:31], v[48:51], v[80:83], v[28:31]
    s_waitcnt vmcnt(20)
    buffer_load_dwordx4 v[184:187], v1, s[24:27], s55 offen offset:1024 nt
    v_mov_b32_dpp v16, v15 row_newbcast:10 row_mask:0xf bank_mask:0xf
    v_mov_b32_dpp v6, v14 quad_perm:[1,0,3,2] row_mask:0xf bank_mask:0xf
    v_perm_b32 v48, v16, v16, v32
    v_perm_b32 v49, v16, v16, v33
    v_perm_b32 v50, v16, v16, v34
    v_perm_b32 v51, v16, v16, v35
    v_mfma_f32_16x16x32_bf16 v[28:31], v[44:47], v[84:87], v[28:31]
    s_waitcnt vmcnt(20)
    buffer_load_dwordx4 v[188:191], v1, s[24:27], s55 offen offset:2048 nt
    v_mov_b32_dpp v16, v15 row_newbcast:12 row_mask:0xf bank_mask:0xf
    v_perm_b32 v44, v16, v16, v32
    v_perm_b32 v45, v16, v16, v33
    v_perm_b32 v46, v16, v16, v34
    v_perm_b32 v47, v16, v16, v35
    v_mfma_f32_16x16x32_bf16 v[28:31], v[48:51], v[88:91], v[28:31]
    s_waitcnt vmcnt(20)
    buffer_load_dwordx4 v[192:195], v1, s[24:27], s55 offen offset:3072 nt
    v_mov_b32_dpp v16, v15 row_newbcast:14 row_mask:0xf bank_mask:0xf
    v_cvt_pk_bf16_f32 v15, v14, v6
    v_perm_b32 v48, v16, v16, v32
    v_perm_b32 v49, v16, v16, v33
    v_perm_b32 v50, v16, v16, v34
    v_perm_b32 v51, v16, v16, v35
    v_mfma_f32_16x16x32_bf16 v[28:31], v[44:47], v[92:95], v[28:31]
    s_add_u32 s54, s54, 0x10000
    s_add_u32 s55, s54, s70
    s_and_b32 s55, s55, 0x1fffff
    s_waitcnt vmcnt(20)
    buffer_load_dwordx4 v[68:71], v1, s[24:27], s55 offen offset:0 nt
    v_mov_b32_dpp v16, v15 row_newbcast:0 row_mask:0xf bank_mask:0xf
    v_perm_b32 v44, v16, v16, v32
    v_perm_b32 v45, v16, v16, v33
    v_perm_b32 v46, v16, v16, v34
    v_perm_b32 v47, v16, v16, v35
    v_mfma_f32_16x16x32_bf16 v[28:31], v[48:51], v[96:99], v[28:31]
    s_waitcnt vmcnt(20)
    buffer_load_dwordx4 v[72:75], v1, s[24:27], s55 offen offset:1024 nt
    v_mov_b32_dpp v16, v15 row_newbcast:2 row_mask:0xf bank_mask:0xf
    v_perm_b32 v48, v16, v16, v32
    v_perm_b32 v49, v16, v16, v33
    v_perm_b32 v50, v16, v16, v34
    v_perm_b32 v51, v16, v16, v35
    v_mfma_f32_16x16x32_bf16 v[28:31], v[44:47], v[100:103], v[28:31]
    s_waitcnt vmcnt(20)
    buffer_load_dwordx4 v[76:79], v1, s[24:27], s55 offen offset:2048 nt
    v_mov_b32_dpp v16, v15 row_newbcast:4 row_mask:0xf bank_mask:0xf
    v_fma_f32 v14, v26, s50, -v4
    v_perm_b32 v44, v16, v16, v32
    v_perm_b32 v45, v16, v16, v33
    v_perm_b32 v46, v16, v16, v34
    v_perm_b32 v47, v16, v16, v35
    v_add_u32 v18, 1, v18
    buffer_store_short v18, v17, s[40:43], 0 offen
    v_mfma_f32_16x16x32_bf16 v[28:31], v[48:51], v[104:107], v[28:31]
    s_waitcnt vmcnt(20)
    buffer_load_dwordx4 v[80:83], v1, s[24:27], s55 offen offset:3072 nt
    v_mov_b32_dpp v16, v15 row_newbcast:6 row_mask:0xf bank_mask:0xf
    v_exp_f32 v14, v14
    v_perm_b32 v48, v16, v16, v32
    v_perm_b32 v49, v16, v16, v33
    v_perm_b32 v50, v16, v16, v34
    v_perm_b32 v51, v16, v16, v35
    v_mfma_f32_16x16x32_bf16 v[28:31], v[44:47], v[108:111], v[28:31]
    s_add_u32 s55, s54, s71
    s_and_b32 s55, s55, 0x1fffff
    s_waitcnt vmcnt(20)
    buffer_load_dwordx4 v[84:87], v1, s[24:27], s55 offen offset:0 nt
    v_mov_b32_dpp v16, v15 row_newbcast:8 row_mask:0xf bank_mask:0xf
    v_add_f32 v5, v5, v14
    v_perm_b32 v44, v16, v16, v32
    v_perm_b32 v45, v16, v16, v33
    v_perm_b32 v46, v16, v16, v34
    v_perm_b32 v47, v16, v16, v35
    v_mfma_f32_16x16x32_bf16 v[28:31], v[48:51], v[112:115], v[28:31]
    s_waitcnt vmcnt(20)
    buffer_load_dwordx4 v[88:91], v1, s[24:27], s55 offen offset:1024 nt
    v_mov_b32_dpp v16, v15 row_newbcast:10 row_mask:0xf bank_mask:0xf
    v_mov_b32_dpp v6, v14 quad_perm:[1,0,3,2] row_mask:0xf bank_mask:0xf
    v_perm_b32 v48, v16, v16, v32
    v_perm_b32 v49, v16, v16, v33
    v_perm_b32 v50, v16, v16, v34
    v_perm_b32 v51, v16, v16, v35
    s_lshl1_add_u32 s52, s51, -1
    s_max_i32 s52, s52, 0
    v_cmp_lt_u32 vcc, s52, v19
    s_and_b32 s60, vcc_lo, 0xffff
    s_bcnt1_i32_b32 s60, s60
    v_cmp_gt_u32 vcc, s52, v19
    s_and_b32 s61, vcc_lo, 0xffff
    s_bcnt1_i32_b32 s61, s61
    v_readlane_b32 s62, v19, s63
    v_mfma_f32_16x16x32_bf16 v[28:31], v[44:47], v[116:119], v[28:31]
    s_waitcnt vmcnt(20)
    buffer_load_dwordx4 v[92:95], v1, s[24:27], s55 offen offset:2048 nt
    v_mov_b32_dpp v16, v15 row_newbcast:12 row_mask:0xf bank_mask:0xf
    v_perm_b32 v44, v16, v16, v32
    v_perm_b32 v45, v16, v16, v33
    v_perm_b32 v46, v16, v16, v34
    v_perm_b32 v47, v16, v16, v35
    v_mfma_f32_16x16x32_bf16 v[28:31], v[48:51], v[120:123], v[28:31]
    s_waitcnt vmcnt(20)
    buffer_load_dwordx4 v[96:99], v1, s[24:27], s55 offen offset:3072 nt
    v_mov_b32_dpp v16, v15 row_newbcast:14 row_mask:0xf bank_mask:0xf
    v_cvt_pk_bf16_f32 v15, v14, v6
    v_perm_b32 v48, v16, v16, v32
    v_perm_b32 v49, v16, v16, v33
    v_perm_b32 v50, v16, v16, v34
    v_perm_b32 v51, v16, v16, v35
    s_sext_i32_i16 s53, s62
    s_sub_i32 s60, s60, s61
    s_add_i32 s60, s60, s53
    s_cmp_gt_i32 s60, -4
    s_cselect_b32 s67, 1, 0
    s_cmp_gt_i32 s60, -1
    s_cselect_b32 s67, 2, s67
    s_cmp_gt_i32 s60, 2
    s_cselect_b32 s67, 3, s67
    s_cmp_gt_i32 s60, 5
    s_cselect_b32 s67, 4, s67
    v_mfma_f32_16x16x32_bf16 v[28:31], v[44:47], v[124:127], v[28:31]
    s_add_u32 s55, s54, s72
    s_and_b32 s55, s55, 0x1fffff
    s_waitcnt vmcnt(20)
    buffer_load_dwordx4 v[100:103], v1, s[24:27], s55 offen offset:0 nt
    v_mov_b32_dpp v16, v15 row_newbcast:0 row_mask:0xf bank_mask:0xf
    v_perm_b32 v44, v16, v16, v32
    v_perm_b32 v45, v16, v16, v33
    v_perm_b32 v46, v16, v16, v34
    v_perm_b32 v47, v16, v16, v35
    s_cmp_lg_u32 s67, 1
    s_cbranch_scc1 L_v_pick
L_v1_u:
    v_mfma_f32_16x16x32_bf16 v[28:31], v[48:51], v[128:131], v[28:31]
    s_waitcnt vmcnt(20)
    buffer_load_dwordx4 v[104:107], v1, s[24:27], s55 offen offset:1024 nt
    v_mov_b32_dpp v16, v15 row_newbcast:2 row_mask:0xf bank_mask:0xf
    v_perm_b32 v48, v16, v16, v32
    v_perm_b32 v49, v16, v16, v33
    v_perm_b32 v50, v16, v16, v34
    v_perm_b32 v51, v16, v16, v35
    v_mfma_f32_16x16x32_bf16 v[28:31], v[44:47], v[132:135], v[28:31]
    s_waitcnt vmcnt(20)
    buffer_load_dwordx4 v[108:111], v1, s[24:27], s55 offen offset:2048 nt
    v_mov_b32_dpp v16, v15 row_newbcast:4 row_mask:0xf bank_mask:0xf
    v_fma_f32 v14, v27, s50, -v4
    v_perm_b32 v44, v16, v16, v32
    v_perm_b32 v45, v16, v16, v33
    v_perm_b32 v46, v16, v16, v34
    v_perm_b32 v47, v16, v16, v35
    buffer_load_ushort v19, v17, s[36:39], 0 offen sc1
    v_mfma_f32_16x16x32_bf16 v[28:31], v[48:51], v[136:139], v[28:31]
    s_waitcnt vmcnt(20)
    buffer_load_dwordx4 v[112:115], v1, s[24:27], s55 offen offset:3072 nt
    v_mov_b32_dpp v16, v15 row_newbcast:6 row_mask:0xf bank_mask:0xf
    ds_read_b128 v[24:27], v3 offset:1024
    v_exp_f32 v14, v14
    v_perm_b32 v48, v16, v16, v32
    v_perm_b32 v49, v16, v16, v33
    v_perm_b32 v50, v16, v16, v34
    v_perm_b32 v51, v16, v16, v35
    v_mfma_f32_16x16x32_bf16 v[28:31], v[44:47], v[140:143], v[28:31]
    s_add_u32 s55, s54, s73
    s_and_b32 s55, s55, 0x1fffff
    s_waitcnt vmcnt(20)
    buffer_load_dwordx4 v[116:119], v1, s[24:27], s55 offen offset:0 nt
    v_mov_b32_dpp v16, v15 row_newbcast:8 row_mask:0xf bank_mask:0xf
    v_add_f32 v5, v5, v14
    v_perm_b32 v44, v16, v16, v32
    v_perm_b32 v45, v16, v16, v33
    v_perm_b32 v46, v16, v16, v34
    v_perm_b32 v47, v16, v16, v35
    v_mfma_f32_16x16x32_bf16 v[28:31], v[48:51], v[144:147], v[28:31]
    s_waitcnt vmcnt(20)
    buffer_load_dwordx4 v[120:123], v1, s[24:27], s55 offen offset:1024 nt
    v_mov_b32_dpp v16, v15 row_newbcast:10 row_mask:0xf bank_mask:0xf
    v_mov_b32_dpp v6, v14 quad_perm:[1,0,3,2] row_mask:0xf bank_mask:0xf
    v_perm_b32 v48, v16, v16, v32
    v_perm_b32 v49, v16, v16, v33
    v_perm_b32 v50, v16, v16, v34
    v_perm_b32 v51, v16, v16, v35
    v_mfma_f32_16x16x32_bf16 v[28:31], v[44:47], v[148:151], v[28:31]
    s_waitcnt vmcnt(20)
    buffer_load_dwordx4 v[124:127], v1, s[24:27], s55 offen offset:2048 nt
    v_mov_b32_dpp v16, v15 row_newbcast:12 row_mask:0xf bank_mask:0xf
    v_perm_b32 v44, v16, v16, v32
    v_perm_b32 v45, v16, v16, v33
    v_perm_b32 v46, v16, v16, v34
    v_perm_b32 v47, v16, v16, v35
    v_mfma_f32_16x16x32_bf16 v[28:31], v[48:51], v[152:155], v[28:31]
    s_waitcnt vmcnt(20)
    buffer_load_dwordx4 v[128:131], v1, s[24:27], s55 offen offset:3072 nt
    v_mov_b32_dpp v16, v15 row_newbcast:14 row_mask:0xf bank_mask:0xf
    v_cvt_pk_bf16_f32 v15, v14, v6
    v_perm_b32 v48, v16, v16, v32
    v_perm_b32 v49, v16, v16, v33
    v_perm_b32 v50, v16, v16, v34
    v_perm_b32 v51, v16, v16, v35
    v_mfma_f32_16x16x32_bf16 v[28:31], v[44:47], v[156:159], v[28:31]
    s_add_u32 s55, s54, s74
    s_and_b32 s55, s55, 0x1fffff
    s_waitcnt vmcnt(20)
    buffer_load_dwordx4 v[132:135], v1, s[24:27], s55 offen offset:0 nt
    v_mov_b32_dpp v16, v15 row_newbcast:0 row_mask:0xf bank_mask:0xf
    v_perm_b32 v44, v16, v16, v32
    v_perm_b32 v45, v16, v16, v33
    v_perm_b32 v46, v16, v16, v34
    v_perm_b32 v47, v16, v16, v35
    v_add_u32 v18, 1, v18
    buffer_store_short v18, v17, s[40:43], 0 offen
    v_mfma_f32_16x16x32_bf16 v[28:31], v[48:51], v[160:163], v[28:31]
    s_waitcnt vmcnt(20)
    buffer_load_dwordx4 v[136:139], v1, s[24:27], s55 offen offset:1024 nt
    v_mov_b32_dpp v16, v15 row_newbcast:2 row_mask:0xf bank_mask:0xf
    v_perm_b32 v48, v16, v16, v32
    v_perm_b32 v49, v16, v16, v33
    v_perm_b32 v50, v16, v16, v34
    v_perm_b32 v51, v16, v16, v35
    v_mfma_f32_16x16x32_bf16 v[28:31], v[44:47], v[164:167], v[28:31]
    s_waitcnt vmcnt(20)
    buffer_load_dwordx4 v[140:143], v1, s[24:27], s55 offen offset:2048 nt
    v_mov_b32_dpp v16, v15 row_newbcast:4 row_mask:0xf bank_mask:0xf
    s_waitcnt lgkmcnt(0)
    v_fma_f32 v14, v24, s50, -v4
    v_perm_b32 v44, v16, v16, v32
    v_perm_b32 v45, v16, v16, v33
    v_perm_b32 v46, v16, v16, v34
    v_perm_b32 v47, v16, v16, v35
    v_mfma_f32_16x16x32_bf16 v[28:31], v[48:51], v[168:171], v[28:31]
    s_waitcnt vmcnt(20)
    buffer_load_dwordx4 v[144:147], v1, s[24:27], s55 offen offset:3072 nt
    v_mov_b32_dpp v16, v15 row_newbcast:6 row_mask:0xf bank_mask:0xf
    v_exp_f32 v14, v14
    v_perm_b32 v48, v16, v16, v32
    v_perm_b32 v49, v16, v16, v33
    v_perm_b32 v50, v16, v16, v34
    v_perm_b32 v51, v16, v16, v35
    s_sub_u32 s52, s51, s64
    s_cmp_lt_u32 s52, 3
    s_cbranch_scc1 L_v1_round
L_v1_t:
    v_mfma_f32_16x16x32_bf16 v[28:31], v[44:47], v[172:175], v[28:31]
    s_add_u32 s55, s54, s75
    s_and_b32 s55, s55, 0x1fffff
    s_waitcnt vmcnt(20)
    buffer_load_dwordx4 v[148:151], v1, s[24:27], s55 offen offset:0 nt
    v_mov_b32_dpp v16, v15 row_newbcast:8 row_mask:0xf bank_mask:0xf
    v_add_f32 v5, v5, v14
    v_perm_b32 v44, v16, v16, v32
    v_perm_b32 v45, v16, v16, v33
    v_perm_b32 v46, v16, v16, v34
    v_perm_b32 v47, v16, v16, v35
    v_mfma_f32_16x16x32_bf16 v[28:31], v[48:51], v[176:179], v[28:31]
    s_waitcnt vmcnt(20)
    buffer_load_dwordx4 v[152:155], v1, s[24:27], s55 offen offset:1024 nt
    v_mov_b32_dpp v16, v15 row_newbcast:10 row_mask:0xf bank_mask:0xf
    v_mov_b32_dpp v6, v14 quad_perm:[1,0,3,2] row_mask:0xf bank_mask:0xf
    v_perm_b32 v48, v16, v16, v32
    v_perm_b32 v49, v16, v16, v33
    v_perm_b32 v50, v16, v16, v34
    v_perm_b32 v51, v16, v16, v35
    v_mfma_f32_16x16x32_bf16 v[28:31], v[44:47], v[180:183], v[28:31]
    s_waitcnt vmcnt(20)
    buffer_load_dwordx4 v[156:159], v1, s[24:27], s55 offen offset:2048 nt
    v_mov_b32_dpp v16, v15 row_newbcast:12 row_mask:0xf bank_mask:0xf
    v_perm_b32 v44, v16, v16, v32
    v_perm_b32 v45, v16, v16, v33
    v_perm_b32 v46, v16, v16, v34
    v_perm_b32 v47, v16, v16, v35
    v_mfma_f32_16x16x32_bf16 v[28:31], v[48:51], v[184:187], v[28:31]
    s_waitcnt vmcnt(20)
    buffer_load_dwordx4 v[160:163], v1, s[24:27], s55 offen offset:3072 nt
    v_mov_b32_dpp v16, v15 row_newbcast:14 row_mask:0xf bank_mask:0xf
    v_cvt_pk_bf16_f32 v15, v14, v6
    v_perm_b32 v48, v16, v16, v32
    v_perm_b32 v49, v16, v16, v33
    v_perm_b32 v50, v16, v16, v34
    v_perm_b32 v51, v16, v16, v35
    v_mfma_f32_16x16x32_bf16 v[28:31], v[44:47], v[188:191], v[28:31]
    s_add_u32 s55, s54, s76
    s_and_b32 s55, s55, 0x1fffff
    s_waitcnt vmcnt(20)
    buffer_load_dwordx4 v[164:167], v1, s[24:27], s55 offen offset:0 nt
    v_mov_b32_dpp v16, v15 row_newbcast:0 row_mask:0xf bank_mask:0xf
    v_perm_b32 v44, v16, v16, v32
    v_perm_b32 v45, v16, v16, v33
    v_perm_b32 v46, v16, v16, v34
    v_perm_b32 v47, v16, v16, v35
    v_mfma_f32_16x16x32_bf16 v[28:31], v[48:51], v[192:195], v[28:31]
    s_waitcnt vmcnt(20)
    buffer_load_dwordx4 v[168:171], v1, s[24:27], s55 offen offset:1024 nt
    v_mov_b32_dpp v16, v15 row_newbcast:2 row_mask:0xf bank_mask:0xf
    v_perm_b32 v48, v16, v16, v32
    v_perm_b32 v49, v16, v16, v33
    v_perm_b32 v50, v16, v16, v34
    v_perm_b32 v51, v16, v16, v35
    s_cmp_eq_u32 s51, 62
    s_cbranch_scc1 L_last
    s_add_u32 s51, s51, 1
    v_add_u32 v3, 1024, v3
    s_branch L_v1
.p2align 6
L_v3:
    v_mfma_f32_16x16x32_bf16 v[28:31], v[44:47], v[68:71], v[28:31]
    s_waitcnt vmcnt(22)
    buffer_load_dwordx4 v[172:175], v1, s[24:27], s55 offen offset:2048 nt
    v_mov_b32_dpp v16, v15 row_newbcast:4 row_mask:0xf bank_mask:0xf
    v_fma_f32 v14, v25, s50, -v4
    v_perm_b32 v44, v16, v16, v32
    v_perm_b32 v45, v16, v16, v33
    v_perm_b32 v46, v16, v16, v34
    v_perm_b32 v47, v16, v16, v35
    v_mfma_f32_16x16x32_bf16 v[28:31], v[48:51], v[72:75], v[28:31]
    s_waitcnt vmcnt(22)
    buffer_load_dwordx4 v[176:179], v1, s[24:27], s55 offen offset:3072 nt
    v_mov_b32_dpp v16, v15 row_newbcast:6 row_mask:0xf bank_mask:0xf
    v_exp_f32 v14, v14
    v_perm_b32 v48, v16, v16, v32
    v_perm_b32 v49, v16, v16, v33
    v_perm_b32 v50, v16, v16, v34
    v_perm_b32 v51, v16, v16, v35
    v_mfma_f32_16x16x32_bf16 v[28:31], v[44:47], v[76:79], v[28:31]
    s_add_u32 s55, s54, s77
    s_and_b32 s55, s55, 0x1fffff
    s_waitcnt vmcnt(22)
    buffer_load_dwordx4 v[180:183], v1, s[24:27], s55 offen offset:0 nt
    v_mov_b32_dpp v16, v15 row_newbcast:8 row_mask:0xf bank_mask:0xf
    v_add_f32 v5, v5, v14
    v_perm_b32 v44, v16, v16, v32
    v_perm_b32 v45, v16, v16, v33
    v_perm_b32 v46, v16, v16, v34
    v_perm_b32 v47, v16, v16, v35
    v_mfma_f32_16x16x32_bf16 v[28:31], v[48:51], v[80:83], v[28:31]
    s_waitcnt vmcnt(22)
    buffer_load_dwordx4 v[184:187], v1, s[24:27], s55 offen offset:1024 nt
    v_mov_b32_dpp v16, v15 row_newbcast:10 row_mask:0xf bank_mask:0xf
    v_mov_b32_dpp v6, v14 quad_perm:[1,0,3,2] row_mask:0xf bank_mask:0xf
    v_perm_b32 v48, v16, v16, v32
    v_perm_b32 v49, v16, v16, v33
    v_perm_b32 v50, v16, v16, v34
    v_perm_b32 v51, v16, v16, v35
    v_mfma_f32_16x16x32_bf16 v[28:31], v[44:47], v[84:87], v[28:31]
    s_waitcnt vmcnt(22)
    buffer_load_dwordx4 v[188:191], v1, s[24:27], s55 offen offset:2048 nt
    v_mov_b32_dpp v16, v15 row_newbcast:12 row_mask:0xf bank_mask:0xf
    v_perm_b32 v44, v16, v16, v32
    v_perm_b32 v45, v16, v16, v33
    v_perm_b32 v46, v16, v16, v34
    v_perm_b32 v47, v16, v16, v35
    v_mfma_f32_16x16x32_bf16 v[28:31], v[48:51], v[88:91], v[28:31]
    s_waitcnt vmcnt(22)
    buffer_load_dwordx4 v[192:195], v1, s[24:27], s55 offen offset:3072 nt
    v_mov_b32_dpp v16, v15 row_newbcast:14 row_mask:0xf bank_mask:0xf
    v_cvt_pk_bf16_f32 v15, v14, v6
    v_perm_b32 v48, v16, v16, v32
    v_perm_b32 v49, v16, v16, v33
    v_perm_b32 v50, v16, v16, v34
    v_perm_b32 v51, v16, v16, v35
    v_mfma_f32_16x16x32_bf16 v[28:31], v[44:47], v[92:95], v[28:31]
    s_add_u32 s54, s54, 0x10000
    s_add_u32 s55, s54, s70
    s_and_b32 s55, s55, 0x1fffff
    s_waitcnt vmcnt(22)
    buffer_load_dwordx4 v[68:71], v1, s[24:27], s55 offen offset:0 nt
    v_mov_b32_dpp v16, v15 row_newbcast:0 row_mask:0xf bank_mask:0xf
    v_perm_b32 v44, v16, v16, v32
    v_perm_b32 v45, v16, v16, v33
    v_perm_b32 v46, v16, v16, v34
    v_perm_b32 v47, v16, v16, v35
    v_mfma_f32_16x16x32_bf16 v[28:31], v[48:51], v[96:99], v[28:31]
    s_waitcnt vmcnt(22)
    buffer_load_dwordx4 v[72:75], v1, s[24:27], s55 offen offset:1024 nt
    v_mov_b32_dpp v16, v15 row_newbcast:2 row_mask:0xf bank_mask:0xf
    v_perm_b32 v48, v16, v16, v32
    v_perm_b32 v49, v16, v16, v33
    v_perm_b32 v50, v16, v16, v34
    v_perm_b32 v51, v16, v16, v35
    v_mfma_f32_16x16x32_bf16 v[28:31], v[44:47], v[100:103], v[28:31]
    s_waitcnt vmcnt(22)
    buffer_load_dwordx4 v[76:79], v1, s[24:27], s55 offen offset:2048 nt
    v_mov_b32_dpp v16, v15 row_newbcast:4 row_mask:0xf bank_mask:0xf
    v_fma_f32 v14, v26, s50, -v4
    v_perm_b32 v44, v16, v16, v32
    v_perm_b32 v45, v16, v16, v33
    v_perm_b32 v46, v16, v16, v34
    v_perm_b32 v47, v16, v16, v35
    v_add_u32 v18, 1, v18
    buffer_store_short v18, v17, s[40:43], 0 offen
    v_mfma_f32_16x16x32_bf16 v[28:31], v[48:51], v[104:107], v[28:31]
    s_waitcnt vmcnt(22)
    buffer_load_dwordx4 v[80:83], v1, s[24:27], s55 offen offset:3072 nt
    v_mov_b32_dpp v16, v15 row_newbcast:6 row_mask:0xf bank_mask:0xf
    v_exp_f32 v14, v14
    v_perm_b32 v48, v16, v16, v32
    v_perm_b32 v49, v16, v16, v33
    v_perm_b32 v50, v16, v16, v34
    v_perm_b32 v51, v16, v16, v35
    v_mfma_f32_16x16x32_bf16 v[28:31], v[44:47], v[108:111], v[28:31]
    s_add_u32 s55, s54, s71
    s_and_b32 s55, s55, 0x1fffff
    s_waitcnt vmcnt(22)
    buffer_load_dwordx4 v[84:87], v1, s[24:27], s55 offen offset:0 nt
    v_mov_b32_dpp v16, v15 row_newbcast:8 row_mask:0xf bank_mask:0xf
    v_add_f32 v5, v5, v14
    v_perm_b32 v44, v16, v16, v32
    v_perm_b32 v45, v16, v16, v33
    v_perm_b32 v46, v16, v16, v34
    v_perm_b32 v47, v16, v16, v35
    v_mfma_f32_16x16x32_bf16 v[28:31], v[48:51], v[112:115], v[28:31]
    s_waitcnt vmcnt(22)
    buffer_load_dwordx4 v[88:91], v1, s[24:27], s55 offen offset:1024 nt
    v_mov_b32_dpp v16, v15 row_newbcast:10 row_mask:0xf bank_mask:0xf
    v_mov_b32_dpp v6, v14 quad_perm:[1,0,3,2] row_mask:0xf bank_mask:0xf
    v_perm_b32 v48, v16, v16, v32
    v_perm_b32 v49, v16, v16, v33
    v_perm_b32 v50, v16, v16, v34
    v_perm_b32 v51, v16, v16, v35
    s_lshl1_add_u32 s52, s51, -1
    s_max_i32 s52, s52, 0
    v_cmp_lt_u32 vcc, s52, v19
    s_and_b32 s60, vcc_lo, 0xffff
    s_bcnt1_i32_b32 s60, s60
    v_cmp_gt_u32 vcc, s52, v19
    s_and_b32 s61, vcc_lo, 0xffff
    s_bcnt1_i32_b32 s61, s61
    v_readlane_b32 s62, v19, s63
    v_mfma_f32_16x16x32_bf16 v[28:31], v[44:47], v[116:119], v[28:31]
    s_waitcnt vmcnt(22)
    buffer_load_dwordx4 v[92:95], v1, s[24:27], s55 offen offset:2048 nt
    v_mov_b32_dpp v16, v15 row_newbcast:12 row_mask:0xf bank_mask:0xf
    v_perm_b32 v44, v16, v16, v32
    v_perm_b32 v45, v16, v16, v33
    v_perm_b32 v46, v16, v16, v34
    v_perm_b32 v47, v16, v16, v35
    v_mfma_f32_16x16x32_bf16 v[28:31], v[48:51], v[120:123], v[28:31]
    s_waitcnt vmcnt(22)
    buffer_load_dwordx4 v[96:99], v1, s[24:27], s55 offen offset:3072 nt
    v_mov_b32_dpp v16, v15 row_newbcast:14 row_mask:0xf bank_mask:0xf
    v_cvt_pk_bf16_f32 v15, v14, v6
    v_perm_b32 v48, v16, v16, v32
    v_perm_b32 v49, v16, v16, v33
    v_perm_b32 v50, v16, v16, v34
    v_perm_b32 v51, v16, v16, v35
    s_sext_i32_i16 s53, s62
    s_sub_i32 s60, s60, s61
    s_add_i32 s60, s60, s53
    s_cmp_gt_i32 s60, -4
    s_cselect_b32 s67, 1, 0
    s_cmp_gt_i32 s60, -1
    s_cselect_b32 s67, 2, s67
    s_cmp_gt_i32 s60, 2
    s_cselect_b32 s67, 3, s67
    s_cmp_gt_i32 s60, 5
    s_cselect_b32 s67, 4, s67
    v_mfma_f32_16x16x32_bf16 v[28:31], v[44:47], v[124:127], v[28:31]
    s_add_u32 s55, s54, s72
    s_and_b32 s55, s55, 0x1fffff
    s_waitcnt vmcnt(22)
    buffer_load_dwordx4 v[100:103], v1, s[24:27], s55 offen offset:0 nt
    v_mov_b32_dpp v16, v15 row_newbcast:0 row_mask:0xf bank_mask:0xf
    v_perm_b32 v44, v16, v16, v32
    v_perm_b32 v45, v16, v16, v33
    v_perm_b32 v46, v16, v16, v34
    v_perm_b32 v47, v16, v16, v35
    s_cmp_lg_u32 s67, 3
    s_cbranch_scc1 L_v_pick
L_v3_u:
    v_mfma_f32_16x16x32_bf16 v[28:31], v[48:51], v[128:131], v[28:31]
    s_waitcnt vmcnt(22)
    buffer_load_dwordx4 v[104:107], v1, s[24:27], s55 offen offset:1024 nt
    v_mov_b32_dpp v16, v15 row_newbcast:2 row_mask:0xf bank_mask:0xf
    v_perm_b32 v48, v16, v16, v32
    v_perm_b32 v49, v16, v16, v33
    v_perm_b32 v50, v16, v16, v34
    v_perm_b32 v51, v16, v16, v35
    v_mfma_f32_16x16x32_bf16 v[28:31], v[44:47], v[132:135], v[28:31]
    s_waitcnt vmcnt(22)
    buffer_load_dwordx4 v[108:111], v1, s[24:27], s55 offen offset:2048 nt
    v_mov_b32_dpp v16, v15 row_newbcast:4 row_mask:0xf bank_mask:0xf
    v_fma_f32 v14, v27, s50, -v4
    v_perm_b32 v44, v16, v16, v32
    v_perm_b32 v45, v16, v16, v33
    v_perm_b32 v46, v16, v16, v34
    v_perm_b32 v47, v16, v16, v35
    buffer_load_ushort v19, v17, s[36:39], 0 offen sc1
    v_mfma_f32_16x16x32_bf16 v[28:31], v[48:51], v[136:139], v[28:31]
    s_waitcnt vmcnt(22)
    buffer_load_dwordx4 v[112:115], v1, s[24:27], s55 offen offset:3072 nt
    v_mov_b32_dpp v16, v15 row_newbcast:6 row_mask:0xf bank_mask:0xf
    ds_read_b128 v[24:27], v3 offset:1024
    v_exp_f32 v14, v14
    v_perm_b32 v48, v16, v16, v32
    v_perm_b32 v49, v16, v16, v33
    v_perm_b32 v50, v16, v16, v34
    v_perm_b32 v51, v16, v16, v35
    v_mfma_f32_16x16x32_bf16 v[28:31], v[44:47], v[140:143], v[28:31]
    s_add_u32 s55, s54, s73
    s_and_b32 s55, s55, 0x1fffff
    s_waitcnt vmcnt(22)
    buffer_load_dwordx4 v[116:119], v1, s[24:27], s55 offen offset:0 nt
    v_mov_b32_dpp v16, v15 row_newbcast:8 row_mask:0xf bank_mask:0xf
    v_add_f32 v5, v5, v14
    v_perm_b32 v44, v16, v16, v32
    v_perm_b32 v45, v16, v16, v33
    v_perm_b32 v46, v16, v16, v34
    v_perm_b32 v47, v16, v16, v35
    v_mfma_f32_16x16x32_bf16 v[28:31], v[48:51], v[144:147], v[28:31]
    s_waitcnt vmcnt(22)
    buffer_load_dwordx4 v[120:123], v1, s[24:27], s55 offen offset:1024 nt
    v_mov_b32_dpp v16, v15 row_newbcast:10 row_mask:0xf bank_mask:0xf
    v_mov_b32_dpp v6, v14 quad_perm:[1,0,3,2] row_mask:0xf bank_mask:0xf
    v_perm_b32 v48, v16, v16, v32
    v_perm_b32 v49, v16, v16, v33
    v_perm_b32 v50, v16, v16, v34
    v_perm_b32 v51, v16, v16, v35
    v_mfma_f32_16x16x32_bf16 v[28:31], v[44:47], v[148:151], v[28:31]
    s_waitcnt vmcnt(22)
    buffer_load_dwordx4 v[124:127], v1, s[24:27], s55 offen offset:2048 nt
    v_mov_b32_dpp v16, v15 row_newbcast:12 row_mask:0xf bank_mask:0xf
    v_perm_b32 v44, v16, v16, v32
    v_perm_b32 v45, v16, v16, v33
    v_perm_b32 v46, v16, v16, v34
    v_perm_b32 v47, v16, v16, v35
    v_mfma_f32_16x16x32_bf16 v[28:31], v[48:51], v[152:155], v[28:31]
    s_waitcnt vmcnt(22)
    buffer_load_dwordx4 v[128:131], v1, s[24:27], s55 offen offset:3072 nt
    v_mov_b32_dpp v16, v15 row_newbcast:14 row_mask:0xf bank_mask:0xf
    v_cvt_pk_bf16_f32 v15, v14, v6
    v_perm_b32 v48, v16, v16, v32
    v_perm_b32 v49, v16, v16, v33
    v_perm_b32 v50, v16, v16, v34
    v_perm_b32 v51, v16, v16, v35
    v_mfma_f32_16x16x32_bf16 v[28:31], v[44:47], v[156:159], v[28:31]
    s_add_u32 s55, s54, s74
    s_and_b32 s55, s55, 0x1fffff
    s_waitcnt vmcnt(22)
    buffer_load_dwordx4 v[132:135], v1, s[24:27], s55 offen offset:0 nt
    v_mov_b32_dpp v16, v15 row_newbcast:0 row_mask:0xf bank_mask:0xf
    v_perm_b32 v44, v16, v16, v32
    v_perm_b32 v45, v16, v16, v33
    v_perm_b32 v46, v16, v16, v34
    v_perm_b32 v47, v16, v16, v35
    v_add_u32 v18, 1, v18
    buffer_store_short v18, v17, s[40:43], 0 offen
    v_mfma_f32_16x16x32_bf16 v[28:31], v[48:51], v[160:163], v[28:31]
    s_waitcnt vmcnt(22)
    buffer_load_dwordx4 v[136:139], v1, s[24:27], s55 offen offset:1024 nt
    v_mov_b32_dpp v16, v15 row_newbcast:2 row_mask:0xf bank_mask:0xf
    v_perm_b32 v48, v16, v16, v32
    v_perm_b32 v49, v16, v16, v33
    v_perm_b32 v50, v16, v16, v34
    v_perm_b32 v51, v16, v16, v35
    v_mfma_f32_16x16x32_bf16 v[28:31], v[44:47], v[164:167], v[28:31]
    s_waitcnt vmcnt(22)
    buffer_load_dwordx4 v[140:143], v1, s[24:27], s55 offen offset:2048 nt
    v_mov_b32_dpp v16, v15 row_newbcast:4 row_mask:0xf bank_mask:0xf
    s_waitcnt lgkmcnt(0)
    v_fma_f32 v14, v24, s50, -v4
    v_perm_b32 v44, v16, v16, v32
    v_perm_b32 v45, v16, v16, v33
    v_perm_b32 v46, v16, v16, v34
    v_perm_b32 v47, v16, v16, v35
    v_mfma_f32_16x16x32_bf16 v[28:31], v[48:51], v[168:171], v[28:31]
    s_waitcnt vmcnt(22)
    buffer_load_dwordx4 v[144:147], v1, s[24:27], s55 offen offset:3072 nt
    v_mov_b32_dpp v16, v15 row_newbcast:6 row_mask:0xf bank_mask:0xf
    v_exp_f32 v14, v14
    v_perm_b32 v48, v16, v16, v32
    v_perm_b32 v49, v16, v16, v33
    v_perm_b32 v50, v16, v16, v34
    v_perm_b32 v51, v16, v16, v35
    s_sub_u32 s52, s51, s64
    s_cmp_lt_u32 s52, 3
    s_cbranch_scc1 L_v3_round
L_v3_t:
    v_mfma_f32_16x16x32_bf16 v[28:31], v[44:47], v[172:175], v[28:31]
    s_add_u32 s55, s54, s75
    s_and_b32 s55, s55, 0x1fffff
    s_waitcnt vmcnt(22)
    buffer_load_dwordx4 v[148:151], v1, s[24:27], s55 offen offset:0 nt
    v_mov_b32_dpp v16, v15 row_newbcast:8 row_mask:0xf bank_mask:0xf
    v_add_f32 v5, v5, v14
    v_perm_b32 v44, v16, v16, v32
    v_perm_b32 v45, v16, v16, v33
    v_perm_b32 v46, v16, v16, v34
    v_perm_b32 v47, v16, v16, v35
    v_mfma_f32_16x16x32_bf16 v[28:31], v[48:51], v[176:179], v[28:31]
    s_waitcnt vmcnt(22)
    buffer_load_dwordx4 v[152:155], v1, s[24:27], s55 offen offset:1024 nt
    v_mov_b32_dpp v16, v15 row_newbcast:10 row_mask:0xf bank_mask:0xf
    v_mov_b32_dpp v6, v14 quad_perm:[1,0,3,2] row_mask:0xf bank_mask:0xf
    v_perm_b32 v48, v16, v16, v32
    v_perm_b32 v49, v16, v16, v33
    v_perm_b32 v50, v16, v16, v34
    v_perm_b32 v51, v16, v16, v35
    v_mfma_f32_16x16x32_bf16 v[28:31], v[44:47], v[180:183], v[28:31]
    s_waitcnt vmcnt(22)
    buffer_load_dwordx4 v[156:159], v1, s[24:27], s55 offen offset:2048 nt
    v_mov_b32_dpp v16, v15 row_newbcast:12 row_mask:0xf bank_mask:0xf
    v_perm_b32 v44, v16, v16, v32
    v_perm_b32 v45, v16, v16, v33
    v_perm_b32 v46, v16, v16, v34
    v_perm_b32 v47, v16, v16, v35
    v_mfma_f32_16x16x32_bf16 v[28:31], v[48:51], v[184:187], v[28:31]
    s_waitcnt vmcnt(22)
    buffer_load_dwordx4 v[160:163], v1, s[24:27], s55 offen offset:3072 nt
    v_mov_b32_dpp v16, v15 row_newbcast:14 row_mask:0xf bank_mask:0xf
    v_cvt_pk_bf16_f32 v15, v14, v6
    v_perm_b32 v48, v16, v16, v32
    v_perm_b32 v49, v16, v16, v33
    v_perm_b32 v50, v16, v16, v34
    v_perm_b32 v51, v16, v16, v35
    v_mfma_f32_16x16x32_bf16 v[28:31], v[44:47], v[188:191], v[28:31]
    s_add_u32 s55, s54, s76
    s_and_b32 s55, s55, 0x1fffff
    s_waitcnt vmcnt(22)
    buffer_load_dwordx4 v[164:167], v1, s[24:27], s55 offen offset:0 nt
    v_mov_b32_dpp v16, v15 row_newbcast:0 row_mask:0xf bank_mask:0xf
    v_perm_b32 v44, v16, v16, v32
    v_perm_b32 v45, v16, v16, v33
    v_perm_b32 v46, v16, v16, v34
    v_perm_b32 v47, v16, v16, v35
    v_mfma_f32_16x16x32_bf16 v[28:31], v[48:51], v[192:195], v[28:31]
    s_waitcnt vmcnt(22)
    buffer_load_dwordx4 v[168:171], v1, s[24:27], s55 offen offset:1024 nt
    v_mov_b32_dpp v16, v15 row_newbcast:2 row_mask:0xf bank_mask:0xf
    v_perm_b32 v48, v16, v16, v32
    v_perm_b32 v49, v16, v16, v33
    v_perm_b32 v50, v16, v16, v34
    v_perm_b32 v51, v16, v16, v35
    s_cmp_eq_u32 s51, 62
    s_cbranch_scc1 L_last
    s_add_u32 s51, s51, 1
    v_add_u32 v3, 1024, v3
    s_branch L_v3
.p2align 6
L_v4:
    v_mfma_f32_16x16x32_bf16 v[28:31], v[44:47], v[68:71], v[28:31]
    s_waitcnt vmcnt(24)
    buffer_load_dwordx4 v[172:175], v1, s[24:27], s55 offen offset:2048 nt
    v_mov_b32_dpp v16, v15 row_newbcast:4 row_mask:0xf bank_mask:0xf
    v_fma_f32 v14, v25, s50, -v4
    v_perm_b32 v44, v16, v16, v32
    v_perm_b32 v45, v16, v16, v33
    v_perm_b32 v46, v16, v16, v34
    v_perm_b32 v47, v16, v16, v35
    v_mfma_f32_16x16x32_bf16 v[28:31], v[48:51], v[72:75], v[28:31]
    s_waitcnt vmcnt(24)
    buffer_load_dwordx4 v[176:179], v1, s[24:27], s55 offen offset:3072 nt
    v_mov_b32_dpp v16, v15 row_newbcast:6 row_mask:0xf bank_mask:0xf
    v_exp_f32 v14, v14
    v_perm_b32 v48, v16, v16, v32
    v_perm_b32 v49, v16, v16, v33
    v_perm_b32 v50, v16, v16, v34
    v_perm_b32 v51, v16, v16, v35
    v_mfma_f32_16x16x32_bf16 v[28:31], v[44:47], v[76:79], v[28:31]
    s_add_u32 s55, s54, s77
    s_and_b32 s55, s55, 0x1fffff
    s_waitcnt vmcnt(24)
    buffer_load_dwordx4 v[180:183], v1, s[24:27], s55 offen offset:0 nt
    v_mov_b32_dpp v16, v15 row_newbcast:8 row_mask:0xf bank_mask:0xf
    v_add_f32 v5, v5, v14
    v_perm_b32 v44, v16, v16, v32
    v_perm_b32 v45, v16, v16, v33
    v_perm_b32 v46, v16, v16, v34
    v_perm_b32 v47, v16, v16, v35
    v_mfma_f32_16x16x32_bf16 v[28:31], v[48:51], v[80:83], v[28:31]
    s_waitcnt vmcnt(24)
    buffer_load_dwordx4 v[184:187], v1, s[24:27], s55 offen offset:1024 nt
    v_mov_b32_dpp v16, v15 row_newbcast:10 row_mask:0xf bank_mask:0xf
    v_mov_b32_dpp v6, v14 quad_perm:[1,0,3,2] row_mask:0xf bank_mask:0xf
    v_perm_b32 v48, v16, v16, v32
    v_perm_b32 v49, v16, v16, v33
    v_perm_b32 v50, v16, v16, v34
    v_perm_b32 v51, v16, v16, v35
    v_mfma_f32_16x16x32_bf16 v[28:31], v[44:47], v[84:87], v[28:31]
    s_waitcnt vmcnt(24)
    buffer_load_dwordx4 v[188:191], v1, s[24:27], s55 offen offset:2048 nt
    v_mov_b32_dpp v16, v15 row_newbcast:12 row_mask:0xf bank_mask:0xf
    v_perm_b32 v44, v16, v16, v32
    v_perm_b32 v45, v16, v16, v33
    v_perm_b32 v46, v16, v16, v34
    v_perm_b32 v47, v16, v16, v35
    v_mfma_f32_16x16x32_bf16 v[28:31], v[48:51], v[88:91], v[28:31]
    s_waitcnt vmcnt(24)
    buffer_load_dwordx4 v[192:195], v1, s[24:27], s55 offen offset:3072 nt
    v_mov_b32_dpp v16, v15 row_newbcast:14 row_mask:0xf bank_mask:0xf
    v_cvt_pk_bf16_f32 v15, v14, v6
    v_perm_b32 v48, v16, v16, v32
    v_perm_b32 v49, v16, v16, v33
    v_perm_b32 v50, v16, v16, v34
    v_perm_b32 v51, v16, v16, v35
    v_mfma_f32_16x16x32_bf16 v[28:31], v[44:47], v[92:95], v[28:31]
    s_add_u32 s54, s54, 0x10000
    s_add_u32 s55, s54, s70
    s_and_b32 s55, s55, 0x1fffff
    s_waitcnt vmcnt(24)
    buffer_load_dwordx4 v[68:71], v1, s[24:27], s55 offen offset:0 nt
    v_mov_b32_dpp v16, v15 row_newbcast:0 row_mask:0xf bank_mask:0xf
    v_perm_b32 v44, v16, v16, v32
    v_perm_b32 v45, v16, v16, v33
    v_perm_b32 v46, v16, v16, v34
    v_perm_b32 v47, v16, v16, v35
    v_mfma_f32_16x16x32_bf16 v[28:31], v[48:51], v[96:99], v[28:31]
    s_waitcnt vmcnt(24)
    buffer_load_dwordx4 v[72:75], v1, s[24:27], s55 offen offset:1024 nt
    v_mov_b32_dpp v16, v15 row_newbcast:2 row_mask:0xf bank_mask:0xf
    v_perm_b32 v48, v16, v16, v32
    v_perm_b32 v49, v16, v16, v33
    v_perm_b32 v50, v16, v16, v34
    v_perm_b32 v51, v16, v16, v35
    v_mfma_f32_16x16x32_bf16 v[28:31], v[44:47], v[100:103], v[28:31]
    s_waitcnt vmcnt(24)
    buffer_load_dwordx4 v[76:79], v1, s[24:27], s55 offen offset:2048 nt
    v_mov_b32_dpp v16, v15 row_newbcast:4 row_mask:0xf bank_mask:0xf
    v_fma_f32 v14, v26, s50, -v4
    v_perm_b32 v44, v16, v16, v32
    v_perm_b32 v45, v16, v16, v33
    v_perm_b32 v46, v16, v16, v34
    v_perm_b32 v47, v16, v16, v35
    v_add_u32 v18, 1, v18
    buffer_store_short v18, v17, s[40:43], 0 offen
    v_mfma_f32_16x16x32_bf16 v[28:31], v[48:51], v[104:107], v[28:31]
    s_waitcnt vmcnt(24)
    buffer_load_dwordx4 v[80:83], v1, s[24:27], s55 offen offset:3072 nt
    v_mov_b32_dpp v16, v15 row_newbcast:6 row_mask:0xf bank_mask:0xf
    v_exp_f32 v14, v14
    v_perm_b32 v48, v16, v16, v32
    v_perm_b32 v49, v16, v16, v33
    v_perm_b32 v50, v16, v16, v34
    v_perm_b32 v51, v16, v16, v35
    v_mfma_f32_16x16x32_bf16 v[28:31], v[44:47], v[108:111], v[28:31]
    s_add_u32 s55, s54, s71
    s_and_b32 s55, s55, 0x1fffff
    s_waitcnt vmcnt(24)
    buffer_load_dwordx4 v[84:87], v1, s[24:27], s55 offen offset:0 nt
    v_mov_b32_dpp v16, v15 row_newbcast:8 row_mask:0xf bank_mask:0xf
    v_add_f32 v5, v5, v14
    v_perm_b32 v44, v16, v16, v32
    v_perm_b32 v45, v16, v16, v33
    v_perm_b32 v46, v16, v16, v34
    v_perm_b32 v47, v16, v16, v35
    v_mfma_f32_16x16x32_bf16 v[28:31], v[48:51], v[112:115], v[28:31]
    s_waitcnt vmcnt(24)
    buffer_load_dwordx4 v[88:91], v1, s[24:27], s55 offen offset:1024 nt
    v_mov_b32_dpp v16, v15 row_newbcast:10 row_mask:0xf bank_mask:0xf
    v_mov_b32_dpp v6, v14 quad_perm:[1,0,3,2] row_mask:0xf bank_mask:0xf
    v_perm_b32 v48, v16, v16, v32
    v_perm_b32 v49, v16, v16, v33
    v_perm_b32 v50, v16, v16, v34
    v_perm_b32 v51, v16, v16, v35
    s_lshl1_add_u32 s52, s51, -1
    s_max_i32 s52, s52, 0
    v_cmp_lt_u32 vcc, s52, v19
    s_and_b32 s60, vcc_lo, 0xffff
    s_bcnt1_i32_b32 s60, s60
    v_cmp_gt_u32 vcc, s52, v19
    s_and_b32 s61, vcc_lo, 0xffff
    s_bcnt1_i32_b32 s61, s61
    v_readlane_b32 s62, v19, s63
    v_mfma_f32_16x16x32_bf16 v[28:31], v[44:47], v[116:119], v[28:31]
    s_waitcnt vmcnt(24)
    buffer_load_dwordx4 v[92:95], v1, s[24:27], s55 offen offset:2048 nt
    v_mov_b32_dpp v16, v15 row_newbcast:12 row_mask:0xf bank_mask:0xf
    v_perm_b32 v44, v16, v16, v32
    v_perm_b32 v45, v16, v16, v33
    v_perm_b32 v46, v16, v16, v34
    v_perm_b32 v47, v16, v16, v35
    v_mfma_f32_16x16x32_bf16 v[28:31], v[48:51], v[120:123], v[28:31]
    s_waitcnt vmcnt(24)
    buffer_load_dwordx4 v[96:99], v1, s[24:27], s55 offen offset:3072 nt
    v_mov_b32_dpp v16, v15 row_newbcast:14 row_mask:0xf bank_mask:0xf
    v_cvt_pk_bf16_f32 v15, v14, v6
    v_perm_b32 v48, v16, v16, v32
    v_perm_b32 v49, v16, v16, v33
    v_perm_b32 v50, v16, v16, v34
    v_perm_b32 v51, v16, v16, v35
    s_sext_i32_i16 s53, s62
    s_sub_i32 s60, s60, s61
    s_add_i32 s60, s60, s53
    s_cmp_gt_i32 s60, -4
    s_cselect_b32 s67, 1, 0
    s_cmp_gt_i32 s60, -1
    s_cselect_b32 s67, 2, s67
    s_cmp_gt_i32 s60, 2
    s_cselect_b32 s67, 3, s67
    s_cmp_gt_i32 s60, 5
    s_cselect_b32 s67, 4, s67
    v_mfma_f32_16x16x32_bf16 v[28:31], v[44:47], v[124:127], v[28:31]
    s_add_u32 s55, s54, s72
    s_and_b32 s55, s55, 0x1fffff
    s_waitcnt vmcnt(24)
    buffer_load_dwordx4 v[100:103], v1, s[24:27], s55 offen offset:0 nt
    v_mov_b32_dpp v16, v15 row_newbcast:0 row_mask:0xf bank_mask:0xf
    v_perm_b32 v44, v16, v16, v32
    v_perm_b32 v45, v16, v16, v33
    v_perm_b32 v46, v16, v16, v34
    v_perm_b32 v47, v16, v16, v35
    s_cmp_lg_u32 s67, 4
    s_cbranch_scc1 L_v_pick
L_v4_u:
    v_mfma_f32_16x16x32_bf16 v[28:31], v[48:51], v[128:131], v[28:31]
    s_waitcnt vmcnt(24)
    buffer_load_dwordx4 v[104:107], v1, s[24:27], s55 offen offset:1024 nt
    v_mov_b32_dpp v16, v15 row_newbcast:2 row_mask:0xf bank_mask:0xf
    v_perm_b32 v48, v16, v16, v32
    v_perm_b32 v49, v16, v16, v33
    v_perm_b32 v50, v16, v16, v34
    v_perm_b32 v51, v16, v16, v35
    v_mfma_f32_16x16x32_bf16 v[28:31], v[44:47], v[132:135], v[28:31]
    s_waitcnt vmcnt(24)
    buffer_load_dwordx4 v[108:111], v1, s[24:27], s55 offen offset:2048 nt
    v_mov_b32_dpp v16, v15 row_newbcast:4 row_mask:0xf bank_mask:0xf
    v_fma_f32 v14, v27, s50, -v4
    v_perm_b32 v44, v16, v16, v32
    v_perm_b32 v45, v16, v16, v33
    v_perm_b32 v46, v16, v16, v34
    v_perm_b32 v47, v16, v16, v35
    buffer_load_ushort v19, v17, s[36:39], 0 offen sc1
    v_mfma_f32_16x16x32_bf16 v[28:31], v[48:51], v[136:139], v[28:31]
    s_waitcnt vmcnt(24)
    buffer_load_dwordx4 v[112:115], v1, s[24:27], s55 offen offset:3072 nt
    v_mov_b32_dpp v16, v15 row_newbcast:6 row_mask:0xf bank_mask:0xf
    ds_read_b128 v[24:27], v3 offset:1024
    v_exp_f32 v14, v14
    v_perm_b32 v48, v16, v16, v32
    v_perm_b32 v49, v16, v16, v33
    v_perm_b32 v50, v16, v16, v34
    v_perm_b32 v51, v16, v16, v35
    v_mfma_f32_16x16x32_bf16 v[28:31], v[44:47], v[140:143], v[28:31]
    s_add_u32 s55, s54, s73
    s_and_b32 s55, s55, 0x1fffff
    s_waitcnt vmcnt(24)
    buffer_load_dwordx4 v[116:119], v1, s[24:27], s55 offen offset:0 nt
    v_mov_b32_dpp v16, v15 row_newbcast:8 row_mask:0xf bank_mask:0xf
    v_add_f32 v5, v5, v14
    v_perm_b32 v44, v16, v16, v32
    v_perm_b32 v45, v16, v16, v33
    v_perm_b32 v46, v16, v16, v34
    v_perm_b32 v47, v16, v16, v35
    v_mfma_f32_16x16x32_bf16 v[28:31], v[48:51], v[144:147], v[28:31]
    s_waitcnt vmcnt(24)
    buffer_load_dwordx4 v[120:123], v1, s[24:27], s55 offen offset:1024 nt
    v_mov_b32_dpp v16, v15 row_newbcast:10 row_mask:0xf bank_mask:0xf
    v_mov_b32_dpp v6, v14 quad_perm:[1,0,3,2] row_mask:0xf bank_mask:0xf
    v_perm_b32 v48, v16, v16, v32
    v_perm_b32 v49, v16, v16, v33
    v_perm_b32 v50, v16, v16, v34
    v_perm_b32 v51, v16, v16, v35
    v_mfma_f32_16x16x32_bf16 v[28:31], v[44:47], v[148:151], v[28:31]
    s_waitcnt vmcnt(24)
    buffer_load_dwordx4 v[124:127], v1, s[24:27], s55 offen offset:2048 nt
    v_mov_b32_dpp v16, v15 row_newbcast:12 row_mask:0xf bank_mask:0xf
    v_perm_b32 v44, v16, v16, v32
    v_perm_b32 v45, v16, v16, v33
    v_perm_b32 v46, v16, v16, v34
    v_perm_b32 v47, v16, v16, v35
    v_mfma_f32_16x16x32_bf16 v[28:31], v[48:51], v[152:155], v[28:31]
    s_waitcnt vmcnt(24)
    buffer_load_dwordx4 v[128:131], v1, s[24:27], s55 offen offset:3072 nt
    v_mov_b32_dpp v16, v15 row_newbcast:14 row_mask:0xf bank_mask:0xf
    v_cvt_pk_bf16_f32 v15, v14, v6
    v_perm_b32 v48, v16, v16, v32
    v_perm_b32 v49, v16, v16, v33
    v_perm_b32 v50, v16, v16, v34
    v_perm_b32 v51, v16, v16, v35
    v_mfma_f32_16x16x32_bf16 v[28:31], v[44:47], v[156:159], v[28:31]
    s_add_u32 s55, s54, s74
    s_and_b32 s55, s55, 0x1fffff
    s_waitcnt vmcnt(24)
    buffer_load_dwordx4 v[132:135], v1, s[24:27], s55 offen offset:0 nt
    v_mov_b32_dpp v16, v15 row_newbcast:0 row_mask:0xf bank_mask:0xf
    v_perm_b32 v44, v16, v16, v32
    v_perm_b32 v45, v16, v16, v33
    v_perm_b32 v46, v16, v16, v34
    v_perm_b32 v47, v16, v16, v35
    v_add_u32 v18, 1, v18
    buffer_store_short v18, v17, s[40:43], 0 offen
    v_mfma_f32_16x16x32_bf16 v[28:31], v[48:51], v[160:163], v[28:31]
    s_waitcnt vmcnt(24)
    buffer_load_dwordx4 v[136:139], v1, s[24:27], s55 offen offset:1024 nt
    v_mov_b32_dpp v16, v15 row_newbcast:2 row_mask:0xf bank_mask:0xf
    v_perm_b32 v48, v16, v16, v32
    v_perm_b32 v49, v16, v16, v33
    v_perm_b32 v50, v16, v16, v34
    v_perm_b32 v51, v16, v16, v35
    v_mfma_f32_16x16x32_bf16 v[28:31], v[44:47], v[164:167], v[28:31]
    s_waitcnt vmcnt(24)
    buffer_load_dwordx4 v[140:143], v1, s[24:27], s55 offen offset:2048 nt
    v_mov_b32_dpp v16, v15 row_newbcast:4 row_mask:0xf bank_mask:0xf
    s_waitcnt lgkmcnt(0)
    v_fma_f32 v14, v24, s50, -v4
    v_perm_b32 v44, v16, v16, v32
    v_perm_b32 v45, v16, v16, v33
    v_perm_b32 v46, v16, v16, v34
    v_perm_b32 v47, v16, v16, v35
    v_mfma_f32_16x16x32_bf16 v[28:31], v[48:51], v[168:171], v[28:31]
    s_waitcnt vmcnt(24)
    buffer_load_dwordx4 v[144:147], v1, s[24:27], s55 offen offset:3072 nt
    v_mov_b32_dpp v16, v15 row_newbcast:6 row_mask:0xf bank_mask:0xf
    v_exp_f32 v14, v14
    v_perm_b32 v48, v16, v16, v32
    v_perm_b32 v49, v16, v16, v33
    v_perm_b32 v50, v16, v16, v34
    v_perm_b32 v51, v16, v16, v35
    s_sub_u32 s52, s51, s64
    s_cmp_lt_u32 s52, 3
    s_cbranch_scc1 L_v4_round
L_v4_t:
    s_cmp_eq_u32 s51, 62
    s_cbranch_scc1 L_soon
    v_mfma_f32_16x16x32_bf16 v[28:31], v[44:47], v[172:175], v[28:31]
    s_add_u32 s55, s54, s75
    s_and_b32 s55, s55, 0x1fffff
    s_waitcnt vmcnt(24)
    buffer_load_dwordx4 v[148:151], v1, s[24:27], s55 offen offset:0 nt
    v_mov_b32_dpp v16, v15 row_newbcast:8 row_mask:0xf bank_mask:0xf
    v_add_f32 v5, v5, v14
    v_perm_b32 v44, v16, v16, v32
    v_perm_b32 v45, v16, v16, v33
    v_perm_b32 v46, v16, v16, v34
    v_perm_b32 v47, v16, v16, v35
    v_mfma_f32_16x16x32_bf16 v[28:31], v[48:51], v[176:179], v[28:31]
    s_waitcnt vmcnt(24)
    buffer_load_dwordx4 v[152:155], v1, s[24:27], s55 offen offset:1024 nt
    v_mov_b32_dpp v16, v15 row_newbcast:10 row_mask:0xf bank_mask:0xf
    v_mov_b32_dpp v6, v14 quad_perm:[1,0,3,2] row_mask:0xf bank_mask:0xf
    v_perm_b32 v48, v16, v16, v32
    v_perm_b32 v49, v16, v16, v33
    v_perm_b32 v50, v16, v16, v34
    v_perm_b32 v51, v16, v16, v35
    v_mfma_f32_16x16x32_bf16 v[28:31], v[44:47], v[180:183], v[28:31]
    s_waitcnt vmcnt(24)
    buffer_load_dwordx4 v[156:159], v1, s[24:27], s55 offen offset:2048 nt
    v_mov_b32_dpp v16, v15 row_newbcast:12 row_mask:0xf bank_mask:0xf
    v_perm_b32 v44, v16, v16, v32
    v_perm_b32 v45, v16, v16, v33
    v_perm_b32 v46, v16, v16, v34
    v_perm_b32 v47, v16, v16, v35
    v_mfma_f32_16x16x32_bf16 v[28:31], v[48:51], v[184:187], v[28:31]
    s_waitcnt vmcnt(24)
    buffer_load_dwordx4 v[160:163], v1, s[24:27], s55 offen offset:3072 nt
    v_mov_b32_dpp v16, v15 row_newbcast:14 row_mask:0xf bank_mask:0xf
    v_cvt_pk_bf16_f32 v15, v14, v6
    v_perm_b32 v48, v16, v16, v32
    v_perm_b32 v49, v16, v16, v33
    v_perm_b32 v50, v16, v16, v34
    v_perm_b32 v51, v16, v16, v35
    v_mfma_f32_16x16x32_bf16 v[28:31], v[44:47], v[188:191], v[28:31]
    s_add_u32 s55, s54, s76
    s_and_b32 s55, s55, 0x1fffff
    s_waitcnt vmcnt(24)
    buffer_load_dwordx4 v[164:167], v1, s[24:27], s55 offen offset:0 nt
    v_mov_b32_dpp v16, v15 row_newbcast:0 row_mask:0xf bank_mask:0xf
    v_perm_b32 v44, v16, v16, v32
    v_perm_b32 v45, v16, v16, v33
    v_perm_b32 v46, v16, v16, v34
    v_perm_b32 v47, v16, v16, v35
    v_mfma_f32_16x16x32_bf16 v[28:31], v[48:51], v[192:195], v[28:31]
    s_waitcnt vmcnt(24)
    buffer_load_dwordx4 v[168:171], v1, s[24:27], s55 offen offset:1024 nt
    v_mov_b32_dpp v16, v15 row_newbcast:2 row_mask:0xf bank_mask:0xf
    v_perm_b32 v48, v16, v16, v32
    v_perm_b32 v49, v16, v16, v33
    v_perm_b32 v50, v16, v16, v34
    v_perm_b32 v51, v16, v16, v35
    s_add_u32 s51, s51, 1
    v_add_u32 v3, 1024, v3
    s_branch L_v4
.p2align 6
L_soon:
    s_add_u32 s55, s54, s75
    s_and_b32 s55, s55, 0x1fffff
    buffer_load_dwordx4 v[148:151], v1, s[24:27], s55 offen offset:0 nt
    buffer_load_dwordx4 v[152:155], v1, s[24:27], s55 offen offset:1024 nt
    buffer_load_dwordx4 v[156:159], v1, s[24:27], s55 offen offset:2048 nt
    buffer_load_dwordx4 v[160:163], v1, s[24:27], s55 offen offset:3072 nt
    s_add_u32 s55, s54, s76
    s_and_b32 s55, s55, 0x1fffff
    buffer_load_dwordx4 v[164:167], v1, s[24:27], s55 offen offset:0 nt
    buffer_load_dwordx4 v[168:171], v1, s[24:27], s55 offen offset:1024 nt
    s_waitcnt vmcnt(31)
    v_mfma_f32_16x16x32_bf16 v[28:31], v[44:47], v[172:175], v[28:31]
    buffer_load_dwordx4 v[172:175], v1, s[24:27], s55 offen offset:2048 nt
    v_mov_b32_dpp v16, v15 row_newbcast:8 row_mask:0xf bank_mask:0xf
    v_add_f32 v5, v5, v14
    v_perm_b32 v44, v16, v16, v32
    v_perm_b32 v45, v16, v16, v33
    v_perm_b32 v46, v16, v16, v34
    v_perm_b32 v47, v16, v16, v35
    s_waitcnt vmcnt(31)
    v_mfma_f32_16x16x32_bf16 v[28:31], v[48:51], v[176:179], v[28:31]
    buffer_load_dwordx4 v[176:179], v1, s[24:27], s55 offen offset:3072 nt
    v_mov_b32_dpp v16, v15 row_newbcast:10 row_mask:0xf bank_mask:0xf
    v_mov_b32_dpp v6, v14 quad_perm:[1,0,3,2] row_mask:0xf bank_mask:0xf
    v_perm_b32 v48, v16, v16, v32
    v_perm_b32 v49, v16, v16, v33
    v_perm_b32 v50, v16, v16, v34
    v_perm_b32 v51, v16, v16, v35
    s_waitcnt vmcnt(31)
    v_mfma_f32_16x16x32_bf16 v[28:31], v[44:47], v[180:183], v[28:31]
    s_add_u32 s55, s54, s77
    s_and_b32 s55, s55, 0x1fffff
    buffer_load_dwordx4 v[180:183], v1, s[24:27], s55 offen offset:0 nt
    v_mov_b32_dpp v16, v15 row_newbcast:12 row_mask:0xf bank_mask:0xf
    v_perm_b32 v44, v16, v16, v32
    v_perm_b32 v45, v16, v16, v33
    v_perm_b32 v46, v16, v16, v34
    v_perm_b32 v47, v16, v16, v35
    s_waitcnt vmcnt(31)
    v_mfma_f32_16x16x32_bf16 v[28:31], v[48:51], v[184:187], v[28:31]
    buffer_load_dwordx4 v[184:187], v1, s[24:27], s55 offen offset:1024 nt
    v_mov_b32_dpp v16, v15 row_newbcast:14 row_mask:0xf bank_mask:0xf
    v_cvt_pk_bf16_f32 v15, v14, v6
    v_perm_b32 v48, v16, v16, v32
    v_perm_b32 v49, v16, v16, v33
    v_perm_b32 v50, v16, v16, v34
    v_perm_b32 v51, v16, v16, v35
    s_waitcnt vmcnt(31)
    v_mfma_f32_16x16x32_bf16 v[28:31], v[44:47], v[188:191], v[28:31]
    buffer_load_dwordx4 v[188:191], v1, s[24:27], s55 offen offset:2048 nt
    v_mov_b32_dpp v16, v15 row_newbcast:0 row_mask:0xf bank_mask:0xf
    v_perm_b32 v44, v16, v16, v32
    v_perm_b32 v45, v16, v16, v33
    v_perm_b32 v46, v16, v16, v34
    v_perm_b32 v47, v16, v16, v35
    s_waitcnt vmcnt(31)
    v_mfma_f32_16x16x32_bf16 v[28:31], v[48:51], v[192:195], v[28:31]
    buffer_load_dwordx4 v[192:195], v1, s[24:27], s55 offen offset:3072 nt
    v_mov_b32_dpp v16, v15 row_newbcast:2 row_mask:0xf bank_mask:0xf
    v_perm_b32 v48, v16, v16, v32
    v_perm_b32 v49, v16, v16, v33
    v_perm_b32 v50, v16, v16, v34
    v_perm_b32 v51, v16, v16, v35
    s_branch L_drain
.p2align 3
L_last:
    buffer_load_dwordx4 v[172:175], v1, s[24:27], s55 offen offset:2048 nt
    buffer_load_dwordx4 v[176:179], v1, s[24:27], s55 offen offset:3072 nt
    s_add_u32 s55, s54, s77
    s_and_b32 s55, s55, 0x1fffff
    buffer_load_dwordx4 v[180:183], v1, s[24:27], s55 offen offset:0 nt
    buffer_load_dwordx4 v[184:187], v1, s[24:27], s55 offen offset:1024 nt
    buffer_load_dwordx4 v[188:191], v1, s[24:27], s55 offen offset:2048 nt
    buffer_load_dwordx4 v[192:195], v1, s[24:27], s55 offen offset:3072 nt
L_drain:
    v_readfirstlane_b32 s52, v20
    s_cmp_eq_u32 s52, 0
    s_cbranch_scc1 L_flag
L_ready:
    s_waitcnt vmcnt(31)
    v_mfma_f32_16x16x32_bf16 v[28:31], v[44:47], v[68:71], v[28:31]
    v_mov_b32_dpp v16, v15 row_newbcast:4 row_mask:0xf bank_mask:0xf
    v_fma_f32 v14, v25, s50, -v4
    v_perm_b32 v52, v16, v16, v32
    v_perm_b32 v53, v16, v16, v33
    v_perm_b32 v54, v16, v16, v34
    v_perm_b32 v55, v16, v16, v35
    v_mov_b32_dpp v16, v15 row_newbcast:6 row_mask:0xf bank_mask:0xf
    v_perm_b32 v56, v16, v16, v32
    v_perm_b32 v57, v16, v16, v33
    v_perm_b32 v58, v16, v16, v34
    v_perm_b32 v59, v16, v16, v35
    s_waitcnt vmcnt(30)
    v_mfma_f32_16x16x32_bf16 v[28:31], v[48:51], v[72:75], v[28:31]
    v_mov_b32_dpp v16, v15 row_newbcast:8 row_mask:0xf bank_mask:0xf
    v_exp_f32 v14, v14
    v_perm_b32 v36, v16, v16, v32
    v_perm_b32 v37, v16, v16, v33
    v_perm_b32 v38, v16, v16, v34
    v_perm_b32 v39, v16, v16, v35
    s_waitcnt vmcnt(29)
    v_mfma_f32_16x16x32_bf16 v[28:31], v[52:55], v[76:79], v[28:31]
    v_mov_b32_dpp v16, v15 row_newbcast:10 row_mask:0xf bank_mask:0xf
    v_mov_b32_dpp v6, v14 quad_perm:[1,0,3,2] row_mask:0xf bank_mask:0xf
    v_add_f32 v5, v5, v14
    v_perm_b32 v40, v16, v16, v32
    v_perm_b32 v41, v16, v16, v33
    v_perm_b32 v42, v16, v16, v34
    v_perm_b32 v43, v16, v16, v35
    s_waitcnt vmcnt(28)
    v_mfma_f32_16x16x32_bf16 v[28:31], v[56:59], v[80:83], v[28:31]
    v_mov_b32_dpp v16, v15 row_newbcast:12 row_mask:0xf bank_mask:0xf
    v_cvt_pk_bf16_f32 v11, v14, v6
    v_perm_b32 v64, v16, v16, v32
    v_perm_b32 v65, v16, v16, v33
    v_perm_b32 v66, v16, v16, v34
    v_perm_b32 v67, v16, v16, v35
    v_mov_b32_dpp v16, v15 row_newbcast:14 row_mask:0xf bank_mask:0xf
    v_perm_b32 v60, v16, v16, v32
    v_perm_b32 v61, v16, v16, v33
    v_perm_b32 v62, v16, v16, v34
    v_perm_b32 v63, v16, v16, v35
    s_waitcnt vmcnt(27)
    v_mfma_f32_16x16x32_bf16 v[28:31], v[36:39], v[84:87], v[28:31]
    v_mov_b32_dpp v16, v11 row_newbcast:0 row_mask:0xf bank_mask:0xf
    v_fma_f32 v14, v26, s50, -v4
    v_perm_b32 v44, v16, v16, v32
    v_perm_b32 v45, v16, v16, v33
    v_perm_b32 v46, v16, v16, v34
    v_perm_b32 v47, v16, v16, v35
    s_waitcnt vmcnt(26)
    v_mfma_f32_16x16x32_bf16 v[28:31], v[40:43], v[88:91], v[28:31]
    v_mov_b32_dpp v16, v11 row_newbcast:2 row_mask:0xf bank_mask:0xf
    v_exp_f32 v14, v14
    v_perm_b32 v48, v16, v16, v32
    v_perm_b32 v49, v16, v16, v33
    v_perm_b32 v50, v16, v16, v34
    v_perm_b32 v51, v16, v16, v35
    s_waitcnt vmcnt(25)
    v_mfma_f32_16x16x32_bf16 v[28:31], v[64:67], v[92:95], v[28:31]
    v_mov_b32_dpp v16, v11 row_newbcast:4 row_mask:0xf bank_mask:0xf
    v_mov_b32_dpp v6, v14 quad_perm:[1,0,3,2] row_mask:0xf bank_mask:0xf
    v_add_f32 v5, v5, v14
    v_perm_b32 v52, v16, v16, v32
    v_perm_b32 v53, v16, v16, v33
    v_perm_b32 v54, v16, v16, v34
    v_perm_b32 v55, v16, v16, v35
    s_waitcnt vmcnt(24)
    v_mfma_f32_16x16x32_bf16 v[28:31], v[60:63], v[96:99], v[28:31]
    v_mov_b32_dpp v16, v11 row_newbcast:6 row_mask:0xf bank_mask:0xf
    v_cvt_pk_bf16_f32 v12, v14, v6
    v_perm_b32 v56, v16, v16, v32
    v_perm_b32 v57, v16, v16, v33
    v_perm_b32 v58, v16, v16, v34
    v_perm_b32 v59, v16, v16, v35
    v_mov_b32_dpp v16, v11 row_newbcast:8 row_mask:0xf bank_mask:0xf
    v_perm_b32 v36, v16, v16, v32
    v_perm_b32 v37, v16, v16, v33
    v_perm_b32 v38, v16, v16, v34
    v_perm_b32 v39, v16, v16, v35
    s_waitcnt vmcnt(23)
    v_mfma_f32_16x16x32_bf16 v[28:31], v[44:47], v[100:103], v[28:31]
    s_mov_b32 s66, 1
    s_atomic_add s66, s[28:29], 18432 glc
    v_mov_b32_dpp v16, v11 row_newbcast:10 row_mask:0xf bank_mask:0xf
    v_fma_f32 v14, v27, s50, -v4
    v_perm_b32 v40, v16, v16, v32
    v_perm_b32 v41, v16, v16, v33
    v_perm_b32 v42, v16, v16, v34
    v_perm_b32 v43, v16, v16, v35
    s_waitcnt vmcnt(22)
    v_mfma_f32_16x16x32_bf16 v[28:31], v[48:51], v[104:107], v[28:31]
    v_mov_b32_dpp v16, v11 row_newbcast:12 row_mask:0xf bank_mask:0xf
    v_exp_f32 v14, v14
    v_perm_b32 v64, v16, v16, v32
    v_perm_b32 v65, v16, v16, v33
    v_perm_b32 v66, v16, v16, v34
    v_perm_b32 v67, v16, v16, v35
    s_waitcnt vmcnt(21)
    v_mfma_f32_16x16x32_bf16 v[28:31], v[52:55], v[108:111], v[28:31]
    v_mov_b32_dpp v16, v11 row_newbcast:14 row_mask:0xf bank_mask:0xf
    v_mov_b32_dpp v6, v14 quad_perm:[1,0,3,2] row_mask:0xf bank_mask:0xf
    v_add_f32 v5, v5, v14
    v_perm_b32 v60, v16, v16, v32
    v_perm_b32 v61, v16, v16, v33
    v_perm_b32 v62, v16, v16, v34
    v_perm_b32 v63, v16, v16, v35
    s_waitcnt vmcnt(20)
    v_mfma_f32_16x16x32_bf16 v[28:31], v[56:59], v[112:115], v[28:31]
    v_mov_b32_dpp v16, v12 row_newbcast:0 row_mask:0xf bank_mask:0xf
    v_cvt_pk_bf16_f32 v18, v14, v6
    v_perm_b32 v44, v16, v16, v32
    v_perm_b32 v45, v16, v16, v33
    v_perm_b32 v46, v16, v16, v34
    v_perm_b32 v47, v16, v16, v35
    v_mov_b32_dpp v16, v12 row_newbcast:2 row_mask:0xf bank_mask:0xf
    v_perm_b32 v48, v16, v16, v32
    v_perm_b32 v49, v16, v16, v33
    v_perm_b32 v50, v16, v16, v34
    v_perm_b32 v51, v16, v16, v35
    s_waitcnt vmcnt(19)
    v_mfma_f32_16x16x32_bf16 v[28:31], v[36:39], v[116:119], v[28:31]
    v_mov_b32_dpp v16, v12 row_newbcast:4 row_mask:0xf bank_mask:0xf
    v_add_f32_dpp v5, v5, v5 quad_perm:[2,3,0,1] row_mask:0xf bank_mask:0xf
    v_lshlrev_b32 v8, 3, v0
    v_perm_b32 v52, v16, v16, v32
    v_perm_b32 v53, v16, v16, v33
    v_perm_b32 v54, v16, v16, v34
    v_perm_b32 v55, v16, v16, v35
    s_waitcnt vmcnt(18)
    v_mfma_f32_16x16x32_bf16 v[28:31], v[40:43], v[120:123], v[28:31]
    v_mov_b32_dpp v16, v12 row_newbcast:6 row_mask:0xf bank_mask:0xf
    v_add_f32_dpp v5, v5, v5 row_ror:4 row_mask:0xf bank_mask:0xf
    v_perm_b32 v56, v16, v16, v32
    v_perm_b32 v57, v16, v16, v33
    v_perm_b32 v58, v16, v16, v34
    v_perm_b32 v59, v16, v16, v35
    s_waitcnt vmcnt(17)
    v_mfma_f32_16x16x32_bf16 v[28:31], v[64:67], v[124:127], v[28:31]
    v_mov_b32_dpp v16, v12 row_newbcast:8 row_mask:0xf bank_mask:0xf
    v_add_f32_dpp v5, v5, v5 row_ror:8 row_mask:0xf bank_mask:0xf
    v_perm_b32 v36, v16, v16, v32
    v_perm_b32 v37, v16, v16, v33
    v_perm_b32 v38, v16, v16, v34
    v_perm_b32 v39, v16, v16, v35
    s_waitcnt vmcnt(16)
    v_mfma_f32_16x16x32_bf16 v[28:31], v[60:63], v[128:131], v[28:31]
    v_mov_b32_dpp v16, v12 row_newbcast:10 row_mask:0xf bank_mask:0xf
    v_mov_b32 v7, v5
    v_perm_b32 v40, v16, v16, v32
    v_perm_b32 v41, v16, v16, v33
    v_perm_b32 v42, v16, v16, v34
    v_perm_b32 v43, v16, v16, v35
    v_mov_b32_dpp v16, v12 row_newbcast:12 row_mask:0xf bank_mask:0xf
    v_perm_b32 v64, v16, v16, v32
    v_perm_b32 v65, v16, v16, v33
    v_perm_b32 v66, v16, v16, v34
    v_perm_b32 v67, v16, v16, v35
    s_waitcnt vmcnt(15)
    v_mfma_f32_16x16x32_bf16 v[28:31], v[44:47], v[132:135], v[28:31]
    v_mov_b32_dpp v16, v12 row_newbcast:14 row_mask:0xf bank_mask:0xf
    v_permlane16_swap_b32 v5, v7
    v_add_f32 v5, v5, v7
    v_perm_b32 v60, v16, v16, v32
    v_perm_b32 v61, v16, v16, v33
    v_perm_b32 v62, v16, v16, v34
    v_perm_b32 v63, v16, v16, v35
    s_waitcnt vmcnt(14)
    v_mfma_f32_16x16x32_bf16 v[28:31], v[48:51], v[136:139], v[28:31]
    v_mov_b32_dpp v16, v18 row_newbcast:0 row_mask:0xf bank_mask:0xf
    v_mov_b32 v7, v5
    v_perm_b32 v44, v16, v16, v32
    v_perm_b32 v45, v16, v16, v33
    v_perm_b32 v46, v16, v16, v34
    v_perm_b32 v47, v16, v16, v35
    s_waitcnt vmcnt(13)
    v_mfma_f32_16x16x32_bf16 v[28:31], v[52:55], v[140:143], v[28:31]
    v_mov_b32_dpp v16, v18 row_newbcast:2 row_mask:0xf bank_mask:0xf
    v_permlane32_swap_b32 v5, v7
    v_add_f32 v5, v5, v7
    v_perm_b32 v48, v16, v16, v32
    v_perm_b32 v49, v16, v16, v33
    v_perm_b32 v50, v16, v16, v34
    v_perm_b32 v51, v16, v16, v35
    s_waitcnt vmcnt(12)
    v_mfma_f32_16x16x32_bf16 v[28:31], v[56:59], v[144:147], v[28:31]
    v_mov_b32_dpp v16, v18 row_newbcast:4 row_mask:0xf bank_mask:0xf
    v_min_u32 v4, -2, v4
    v_min_u32 v5, -2, v5
    v_perm_b32 v52, v16, v16, v32
    v_perm_b32 v53, v16, v16, v33
    v_perm_b32 v54, v16, v16, v34
    v_perm_b32 v55, v16, v16, v35
    v_mov_b32_dpp v16, v18 row_newbcast:6 row_mask:0xf bank_mask:0xf
    v_perm_b32 v56, v16, v16, v32
    v_perm_b32 v57, v16, v16, v33
    v_perm_b32 v58, v16, v16, v34
    v_perm_b32 v59, v16, v16, v35
    s_waitcnt vmcnt(11)
    v_mfma_f32_16x16x32_bf16 v[28:31], v[36:39], v[148:151], v[28:31]
    v_mov_b32_dpp v16, v18 row_newbcast:8 row_mask:0xf bank_mask:0xf
    v_perm_b32 v36, v16, v16, v32
    v_perm_b32 v37, v16, v16, v33
    v_perm_b32 v38, v16, v16, v34
    v_perm_b32 v39, v16, v16, v35
    s_waitcnt vmcnt(10)
    v_mfma_f32_16x16x32_bf16 v[28:31], v[40:43], v[152:155], v[28:31]
    v_mov_b32_dpp v16, v18 row_newbcast:10 row_mask:0xf bank_mask:0xf
    v_perm_b32 v40, v16, v16, v32
    v_perm_b32 v41, v16, v16, v33
    v_perm_b32 v42, v16, v16, v34
    v_perm_b32 v43, v16, v16, v35
    s_waitcnt vmcnt(9)
    v_mfma_f32_16x16x32_bf16 v[28:31], v[64:67], v[156:159], v[28:31]
    v_mov_b32_dpp v16, v18 row_newbcast:12 row_mask:0xf bank_mask:0xf
    v_perm_b32 v64, v16, v16, v32
    v_perm_b32 v65, v16, v16, v33
    v_perm_b32 v66, v16, v16, v34
    v_perm_b32 v67, v16, v16, v35
    s_waitcnt vmcnt(8)
    v_mfma_f32_16x16x32_bf16 v[28:31], v[60:63], v[160:163], v[28:31]
    v_mov_b32_dpp v16, v18 row_newbcast:14 row_mask:0xf bank_mask:0xf
    v_perm_b32 v60, v16, v16, v32
    v_perm_b32 v61, v16, v16, v33
    v_perm_b32 v62, v16, v16, v34
    v_perm_b32 v63, v16, v16, v35
    s_waitcnt vmcnt(7)
    v_mfma_f32_16x16x32_bf16 v[28:31], v[44:47], v[164:167], v[28:31]
    s_waitcnt vmcnt(6)
    v_mfma_f32_16x16x32_bf16 v[28:31], v[48:51], v[168:171], v[28:31]
    s_waitcnt vmcnt(5)
    v_mfma_f32_16x16x32_bf16 v[28:31], v[52:55], v[172:175], v[28:31]
    s_waitcnt vmcnt(4)
    v_mfma_f32_16x16x32_bf16 v[28:31], v[56:59], v[176:179], v[28:31]
    s_waitcnt vmcnt(3)
    v_mfma_f32_16x16x32_bf16 v[28:31], v[36:39], v[180:183], v[28:31]
    s_waitcnt vmcnt(2)
    v_mfma_f32_16x16x32_bf16 v[28:31], v[40:43], v[184:187], v[28:31]
    s_waitcnt vmcnt(1)
    v_mfma_f32_16x16x32_bf16 v[28:31], v[64:67], v[188:191], v[28:31]
    s_waitcnt vmcnt(0)
    v_mfma_f32_16x16x32_bf16 v[28:31], v[60:63], v[192:195], v[28:31]
    s_waitcnt lgkmcnt(0)
    s_cmp_eq_u32 s66, 15
    s_nop 5
    v_min_u32 v28, -2, v28
    v_min_u32 v29, -2, v29
    v_min_u32 v30, -2, v30
    v_min_u32 v31, -2, v31
    s_cbranch_scc1 L_merge
    buffer_store_dwordx4 v[28:31], v2, s[28:31], s68 offen sc1
    s_mov_b64 exec, 0xffff
    buffer_store_dwordx2 v[4:5], v8, s[28:31], s68 offen offset:1024 sc1
    s_endpgm
.p2align 3
    s_nop 0
L_merge:
    buffer_store_dwordx4 v[28:31], v2, s[28:31], s68 offen
    s_mov_b64 exec, 0xffff
    buffer_store_dwordx2 v[4:5], v8, s[28:31], s68 offen offset:1024
    s_mov_b64 exec, -1
    v_lshrrev_b32 v6, 5, v0
    v_and_b32 v7, 15, v0
    v_mul_u32_u24 v13, 1152, v7
    v_lshl_add_u32 v13, v6, 3, v13
    v_lshlrev_b32 v20, 8, v6
    v_lshl_add_u32 v20, v7, 4, v20
    v_bfe_u32 v6, v0, 4, 1
    v_lshl_add_u32 v20, v6, 3, v20
    s_lshl_b32 s52, s48, 9
    s_add_u32 s24, s16, s52
    s_addc_u32 s25, s17, 0
    s_movk_i32 s71, 3456
    s_movk_i32 s72, 6912
    s_movk_i32 s73, 10368
    s_movk_i32 s74, 13824
    s_movk_i32 s75, 17280
L_get0:
    buffer_load_dwordx2 v[24:25], v13, s[28:31], 0 offen offset:1024 sc1
    buffer_load_dwordx4 v[68:71], v2, s[28:31], 0 offen offset:0 sc1
    buffer_load_dwordx4 v[72:75], v2, s[28:31], 0 offen offset:1152 sc1
    buffer_load_dwordx4 v[76:79], v2, s[28:31], 0 offen offset:2304 sc1
    buffer_load_dwordx4 v[80:83], v2, s[28:31], s71 offen offset:0 sc1
    buffer_load_dwordx4 v[84:87], v2, s[28:31], s71 offen offset:1152 sc1
    buffer_load_dwordx4 v[88:91], v2, s[28:31], s71 offen offset:2304 sc1
    buffer_load_dwordx4 v[92:95], v2, s[28:31], s72 offen offset:0 sc1
    buffer_load_dwordx4 v[96:99], v2, s[28:31], s72 offen offset:1152 sc1
    buffer_load_dwordx4 v[100:103], v2, s[28:31], s72 offen offset:2304 sc1
    buffer_load_dwordx4 v[104:107], v2, s[28:31], s73 offen offset:0 sc1
    buffer_load_dwordx4 v[108:111], v2, s[28:31], s73 offen offset:1152 sc1
    buffer_load_dwordx4 v[112:115], v2, s[28:31], s73 offen offset:2304 sc1
    buffer_load_dwordx4 v[116:119], v2, s[28:31], s74 offen offset:0 sc1
    buffer_load_dwordx4 v[120:123], v2, s[28:31], s74 offen offset:1152 sc1
    buffer_load_dwordx4 v[124:127], v2, s[28:31], s74 offen offset:2304 sc1
    buffer_load_dwordx4 v[128:131], v2, s[28:31], s75 offen offset:0 sc1
    s_waitcnt vmcnt(16)
    v_max_f32_dpp v10, v24, v24 row_ror:1 row_mask:0xf bank_mask:0xf
    v_max_u32 v6, v24, v25
    v_cmp_eq_u32 vcc, -1, v6
    v_max_f32_dpp v10, v10, v10 row_ror:2 row_mask:0xf bank_mask:0xf
    s_cbranch_vccnz L_get0
    s_nop 0
    v_max_f32_dpp v10, v10, v10 row_ror:4 row_mask:0xf bank_mask:0xf
    s_nop 1
    v_max_f32_dpp v10, v10, v10 row_ror:8 row_mask:0xf bank_mask:0xf
    v_sub_f32 v11, v24, v10
    v_exp_f32 v11, v11
    s_nop 0
    v_mul_f32 v12, v25, v11
    s_waitcnt vmcnt(11)
    v_mul_f32_dpp v28, v11, v68 row_newbcast:0 row_mask:0xf bank_mask:0xf
    v_mul_f32_dpp v29, v11, v69 row_newbcast:0 row_mask:0xf bank_mask:0xf
    v_mul_f32_dpp v30, v11, v70 row_newbcast:0 row_mask:0xf bank_mask:0xf
    v_mul_f32_dpp v31, v11, v71 row_newbcast:0 row_mask:0xf bank_mask:0xf
    v_add_f32_dpp v12, v12, v12 row_ror:1 row_mask:0xf bank_mask:0xf
    v_fmac_f32_dpp v28, v11, v72 row_newbcast:1 row_mask:0xf bank_mask:0xf
    v_fmac_f32_dpp v29, v11, v73 row_newbcast:1 row_mask:0xf bank_mask:0xf
    v_fmac_f32_dpp v30, v11, v74 row_newbcast:1 row_mask:0xf bank_mask:0xf
    v_fmac_f32_dpp v31, v11, v75 row_newbcast:1 row_mask:0xf bank_mask:0xf
    v_add_f32_dpp v12, v12, v12 row_ror:2 row_mask:0xf bank_mask:0xf
    v_fmac_f32_dpp v28, v11, v76 row_newbcast:2 row_mask:0xf bank_mask:0xf
    v_fmac_f32_dpp v29, v11, v77 row_newbcast:2 row_mask:0xf bank_mask:0xf
    v_fmac_f32_dpp v30, v11, v78 row_newbcast:2 row_mask:0xf bank_mask:0xf
    v_fmac_f32_dpp v31, v11, v79 row_newbcast:2 row_mask:0xf bank_mask:0xf
    v_add_f32_dpp v12, v12, v12 row_ror:4 row_mask:0xf bank_mask:0xf
    v_fmac_f32_dpp v28, v11, v80 row_newbcast:3 row_mask:0xf bank_mask:0xf
    v_fmac_f32_dpp v29, v11, v81 row_newbcast:3 row_mask:0xf bank_mask:0xf
    v_fmac_f32_dpp v30, v11, v82 row_newbcast:3 row_mask:0xf bank_mask:0xf
    v_fmac_f32_dpp v31, v11, v83 row_newbcast:3 row_mask:0xf bank_mask:0xf
    v_add_f32_dpp v12, v12, v12 row_ror:8 row_mask:0xf bank_mask:0xf
    v_fmac_f32_dpp v28, v11, v84 row_newbcast:4 row_mask:0xf bank_mask:0xf
    v_fmac_f32_dpp v29, v11, v85 row_newbcast:4 row_mask:0xf bank_mask:0xf
    v_fmac_f32_dpp v30, v11, v86 row_newbcast:4 row_mask:0xf bank_mask:0xf
    v_fmac_f32_dpp v31, v11, v87 row_newbcast:4 row_mask:0xf bank_mask:0xf
    s_waitcnt vmcnt(6)
    v_rcp_f32 v12, v12
    v_fmac_f32_dpp v28, v11, v88 row_newbcast:5 row_mask:0xf bank_mask:0xf
    v_fmac_f32_dpp v29, v11, v89 row_newbcast:5 row_mask:0xf bank_mask:0xf
    v_fmac_f32_dpp v30, v11, v90 row_newbcast:5 row_mask:0xf bank_mask:0xf
    v_fmac_f32_dpp v31, v11, v91 row_newbcast:5 row_mask:0xf bank_mask:0xf
    v_fmac_f32_dpp v28, v11, v92 row_newbcast:6 row_mask:0xf bank_mask:0xf
    v_fmac_f32_dpp v29, v11, v93 row_newbcast:6 row_mask:0xf bank_mask:0xf
    v_fmac_f32_dpp v30, v11, v94 row_newbcast:6 row_mask:0xf bank_mask:0xf
    v_fmac_f32_dpp v31, v11, v95 row_newbcast:6 row_mask:0xf bank_mask:0xf
    v_fmac_f32_dpp v28, v11, v96 row_newbcast:7 row_mask:0xf bank_mask:0xf
    v_fmac_f32_dpp v29, v11, v97 row_newbcast:7 row_mask:0xf bank_mask:0xf
    v_fmac_f32_dpp v30, v11, v98 row_newbcast:7 row_mask:0xf bank_mask:0xf
    v_fmac_f32_dpp v31, v11, v99 row_newbcast:7 row_mask:0xf bank_mask:0xf
    v_fmac_f32_dpp v28, v11, v100 row_newbcast:8 row_mask:0xf bank_mask:0xf
    v_fmac_f32_dpp v29, v11, v101 row_newbcast:8 row_mask:0xf bank_mask:0xf
    v_fmac_f32_dpp v30, v11, v102 row_newbcast:8 row_mask:0xf bank_mask:0xf
    v_fmac_f32_dpp v31, v11, v103 row_newbcast:8 row_mask:0xf bank_mask:0xf
    v_fmac_f32_dpp v28, v11, v104 row_newbcast:9 row_mask:0xf bank_mask:0xf
    v_fmac_f32_dpp v29, v11, v105 row_newbcast:9 row_mask:0xf bank_mask:0xf
    v_fmac_f32_dpp v30, v11, v106 row_newbcast:9 row_mask:0xf bank_mask:0xf
    v_fmac_f32_dpp v31, v11, v107 row_newbcast:9 row_mask:0xf bank_mask:0xf
    s_waitcnt vmcnt(0)
    s_movk_i32 s26, 512
    v_fmac_f32_dpp v28, v11, v108 row_newbcast:10 row_mask:0xf bank_mask:0xf
    v_fmac_f32_dpp v29, v11, v109 row_newbcast:10 row_mask:0xf bank_mask:0xf
    v_fmac_f32_dpp v30, v11, v110 row_newbcast:10 row_mask:0xf bank_mask:0xf
    v_fmac_f32_dpp v31, v11, v111 row_newbcast:10 row_mask:0xf bank_mask:0xf
    v_fmac_f32_dpp v28, v11, v112 row_newbcast:11 row_mask:0xf bank_mask:0xf
    v_fmac_f32_dpp v29, v11, v113 row_newbcast:11 row_mask:0xf bank_mask:0xf
    v_fmac_f32_dpp v30, v11, v114 row_newbcast:11 row_mask:0xf bank_mask:0xf
    v_fmac_f32_dpp v31, v11, v115 row_newbcast:11 row_mask:0xf bank_mask:0xf
    v_fmac_f32_dpp v28, v11, v116 row_newbcast:12 row_mask:0xf bank_mask:0xf
    v_fmac_f32_dpp v29, v11, v117 row_newbcast:12 row_mask:0xf bank_mask:0xf
    v_fmac_f32_dpp v30, v11, v118 row_newbcast:12 row_mask:0xf bank_mask:0xf
    v_fmac_f32_dpp v31, v11, v119 row_newbcast:12 row_mask:0xf bank_mask:0xf
    v_fmac_f32_dpp v28, v11, v120 row_newbcast:13 row_mask:0xf bank_mask:0xf
    v_fmac_f32_dpp v29, v11, v121 row_newbcast:13 row_mask:0xf bank_mask:0xf
    v_fmac_f32_dpp v30, v11, v122 row_newbcast:13 row_mask:0xf bank_mask:0xf
    v_fmac_f32_dpp v31, v11, v123 row_newbcast:13 row_mask:0xf bank_mask:0xf
    v_fmac_f32_dpp v28, v11, v124 row_newbcast:14 row_mask:0xf bank_mask:0xf
    v_fmac_f32_dpp v29, v11, v125 row_newbcast:14 row_mask:0xf bank_mask:0xf
    v_fmac_f32_dpp v30, v11, v126 row_newbcast:14 row_mask:0xf bank_mask:0xf
    v_fmac_f32_dpp v31, v11, v127 row_newbcast:14 row_mask:0xf bank_mask:0xf
    v_fmac_f32_dpp v28, v11, v128 row_newbcast:15 row_mask:0xf bank_mask:0xf
    v_fmac_f32_dpp v29, v11, v129 row_newbcast:15 row_mask:0xf bank_mask:0xf
    v_fmac_f32_dpp v30, v11, v130 row_newbcast:15 row_mask:0xf bank_mask:0xf
    v_fmac_f32_dpp v31, v11, v131 row_newbcast:15 row_mask:0xf bank_mask:0xf
    v_cmp_u_f32 vcc, v28, v29
    v_cmp_u_f32 s[60:61], v30, v31
    v_mul_f32 v28, v28, v12
    v_mul_f32 v29, v29, v12
    v_mul_f32 v30, v30, v12
    v_mul_f32 v31, v31, v12
    s_or_b64 vcc, vcc, s[60:61]
    v_cvt_pk_bf16_f32 v4, v28, v29
    v_cvt_pk_bf16_f32 v5, v30, v31
    s_cbranch_scc1 L_nan0
L_out:
    buffer_store_dwordx2 v[4:5], v20, s[24:27], 0 offen
L_end:
    s_endpgm
L_nan0:
    v_max_u32 v6, v68, v69
    v_max3_u32 v6, v6, v70, v71
    v_max3_u32 v6, v6, v72, v73
    v_max3_u32 v6, v6, v74, v75
    v_max3_u32 v6, v6, v76, v77
    v_max3_u32 v6, v6, v78, v79
    v_max3_u32 v6, v6, v80, v81
    v_max3_u32 v6, v6, v82, v83
    v_max3_u32 v6, v6, v84, v85
    v_max3_u32 v6, v6, v86, v87
    v_max3_u32 v6, v6, v88, v89
    v_max3_u32 v6, v6, v90, v91
    v_max3_u32 v6, v6, v92, v93
    v_max3_u32 v6, v6, v94, v95
    v_max3_u32 v6, v6, v96, v97
    v_max3_u32 v6, v6, v98, v99
    v_max3_u32 v6, v6, v100, v101
    v_max3_u32 v6, v6, v102, v103
    v_max3_u32 v6, v6, v104, v105
    v_max3_u32 v6, v6, v106, v107
    v_max3_u32 v6, v6, v108, v109
    v_max3_u32 v6, v6, v110, v111
    v_max3_u32 v6, v6, v112, v113
    v_max3_u32 v6, v6, v114, v115
    v_max3_u32 v6, v6, v116, v117
    v_max3_u32 v6, v6, v118, v119
    v_max3_u32 v6, v6, v120, v121
    v_max3_u32 v6, v6, v122, v123
    v_max3_u32 v6, v6, v124, v125
    v_max3_u32 v6, v6, v126, v127
    v_max3_u32 v6, v6, v128, v129
    v_max3_u32 v6, v6, v130, v131
    v_cmp_eq_u32 vcc, -1, v6
    s_cbranch_vccnz L_get0
    s_branch L_out
L_flag:
    buffer_load_dword v20, off, s[32:35], 0 sc1
    s_waitcnt vmcnt(0)
    v_readfirstlane_b32 s52, v20
    s_cmp_eq_u32 s52, 0
    s_cbranch_scc1 L_flag
    s_branch L_ready
L_extra:
    s_cmp_lg_u32 s2, 256
    s_cbranch_scc1 L_end
    v_mul_u32_u24 v6, 20736, v0
    v_mov_b32 v7, 0
    v_mov_b32 v8, 1
    s_mov_b32 s30, 995328
    s_mov_b32 s31, 0x20000
    s_mov_b32 s34, 4
    s_mov_b32 s35, 0x20000
    s_mov_b32 s52, 18432
    s_waitcnt lgkmcnt(0)
    s_mov_b64 s[28:29], s[20:21]
    s_mov_b64 s[32:33], s[18:19]
    buffer_store_dword v7, v6, s[28:31], s52 offen sc1
    s_mov_b64 exec, 1
    s_waitcnt vmcnt(0)
    buffer_store_dword v8, off, s[32:35], 0 sc1
    s_endpgm
L_k_pick:
    s_cmp_eq_u32 s67, 2
    s_cbranch_scc1 L_k2_u
    s_cmp_eq_u32 s67, 0
    s_cbranch_scc1 L_k0_u
    s_cmp_eq_u32 s67, 1
    s_cbranch_scc1 L_k1_u
    s_cmp_eq_u32 s67, 3
    s_cbranch_scc1 L_k3_u
    s_branch L_k4_u
L_v_pick:
    s_cmp_eq_u32 s67, 2
    s_cbranch_scc1 L_v2_u
    s_cmp_eq_u32 s67, 0
    s_cbranch_scc1 L_v0_u
    s_cmp_eq_u32 s67, 1
    s_cbranch_scc1 L_v1_u
    s_cmp_eq_u32 s67, 3
    s_cbranch_scc1 L_v3_u
    s_branch L_v4_u
L_k2_round:
    s_cmp_eq_u32 s52, 2
    s_cbranch_scc1 L_k2_bias
    s_cmp_eq_u32 s52, 1
    s_cbranch_scc1 L_k2_take
    buffer_load_dword v20, off, s[32:35], 0 sc1
    s_branch L_k2_t
L_k2_take:
    v_readfirstlane_b32 s52, v20
    s_cmp_eq_u32 s52, 0
    s_cselect_b32 s64, 0x7fff, s64
    s_cbranch_scc1 L_k2_t
    s_mov_b32 s66, 1
    s_atomic_add s66, s[20:21], s65 glc
    s_branch L_k2_t
L_k2_bias:
    s_waitcnt lgkmcnt(0)
    s_lshl1_add_u32 s52, s66, -7
    s_sext_i32_i16 s53, s62
    s_min_i32 s53, s53, 0
    s_max_i32 s53, s53, -16
    s_mul_i32 s53, s53, 2
    s_cmp_lt_i32 s52, 0
    s_cselect_b32 s53, s53, 0
    s_add_i32 s52, s52, s53
    s_add_i32 s52, s52, 2
    s_ashr_i32 s52, s52, 2
    v_mov_b32 v8, s52
    v_lshlrev_b32 v9, 7, v0
    buffer_store_short v8, v9, s[44:47], 0 offen
    s_branch L_k2_t
L_k0_round:
    s_cmp_eq_u32 s52, 2
    s_cbranch_scc1 L_k0_bias
    s_cmp_eq_u32 s52, 1
    s_cbranch_scc1 L_k0_take
    buffer_load_dword v20, off, s[32:35], 0 sc1
    s_branch L_k0_t
L_k0_take:
    v_readfirstlane_b32 s52, v20
    s_cmp_eq_u32 s52, 0
    s_cselect_b32 s64, 0x7fff, s64
    s_cbranch_scc1 L_k0_t
    s_mov_b32 s66, 1
    s_atomic_add s66, s[20:21], s65 glc
    s_branch L_k0_t
L_k0_bias:
    s_waitcnt lgkmcnt(0)
    s_lshl1_add_u32 s52, s66, -7
    s_sext_i32_i16 s53, s62
    s_min_i32 s53, s53, 0
    s_max_i32 s53, s53, -16
    s_mul_i32 s53, s53, 2
    s_cmp_lt_i32 s52, 0
    s_cselect_b32 s53, s53, 0
    s_add_i32 s52, s52, s53
    s_add_i32 s52, s52, 2
    s_ashr_i32 s52, s52, 2
    v_mov_b32 v8, s52
    v_lshlrev_b32 v9, 7, v0
    buffer_store_short v8, v9, s[44:47], 0 offen
    s_branch L_k0_t
L_k1_round:
    s_cmp_eq_u32 s52, 2
    s_cbranch_scc1 L_k1_bias
    s_cmp_eq_u32 s52, 1
    s_cbranch_scc1 L_k1_take
    buffer_load_dword v20, off, s[32:35], 0 sc1
    s_branch L_k1_t
L_k1_take:
    v_readfirstlane_b32 s52, v20
    s_cmp_eq_u32 s52, 0
    s_cselect_b32 s64, 0x7fff, s64
    s_cbranch_scc1 L_k1_t
    s_mov_b32 s66, 1
    s_atomic_add s66, s[20:21], s65 glc
    s_branch L_k1_t
L_k1_bias:
    s_waitcnt lgkmcnt(0)
    s_lshl1_add_u32 s52, s66, -7
    s_sext_i32_i16 s53, s62
    s_min_i32 s53, s53, 0
    s_max_i32 s53, s53, -16
    s_mul_i32 s53, s53, 2
    s_cmp_lt_i32 s52, 0
    s_cselect_b32 s53, s53, 0
    s_add_i32 s52, s52, s53
    s_add_i32 s52, s52, 2
    s_ashr_i32 s52, s52, 2
    v_mov_b32 v8, s52
    v_lshlrev_b32 v9, 7, v0
    buffer_store_short v8, v9, s[44:47], 0 offen
    s_branch L_k1_t
L_k3_round:
    s_cmp_eq_u32 s52, 2
    s_cbranch_scc1 L_k3_bias
    s_cmp_eq_u32 s52, 1
    s_cbranch_scc1 L_k3_take
    buffer_load_dword v20, off, s[32:35], 0 sc1
    s_branch L_k3_t
L_k3_take:
    v_readfirstlane_b32 s52, v20
    s_cmp_eq_u32 s52, 0
    s_cselect_b32 s64, 0x7fff, s64
    s_cbranch_scc1 L_k3_t
    s_mov_b32 s66, 1
    s_atomic_add s66, s[20:21], s65 glc
    s_branch L_k3_t
L_k3_bias:
    s_waitcnt lgkmcnt(0)
    s_lshl1_add_u32 s52, s66, -7
    s_sext_i32_i16 s53, s62
    s_min_i32 s53, s53, 0
    s_max_i32 s53, s53, -16
    s_mul_i32 s53, s53, 2
    s_cmp_lt_i32 s52, 0
    s_cselect_b32 s53, s53, 0
    s_add_i32 s52, s52, s53
    s_add_i32 s52, s52, 2
    s_ashr_i32 s52, s52, 2
    v_mov_b32 v8, s52
    v_lshlrev_b32 v9, 7, v0
    buffer_store_short v8, v9, s[44:47], 0 offen
    s_branch L_k3_t
L_k4_round:
    s_cmp_eq_u32 s52, 2
    s_cbranch_scc1 L_k4_bias
    s_cmp_eq_u32 s52, 1
    s_cbranch_scc1 L_k4_take
    buffer_load_dword v20, off, s[32:35], 0 sc1
    s_branch L_k4_t
L_k4_take:
    v_readfirstlane_b32 s52, v20
    s_cmp_eq_u32 s52, 0
    s_cselect_b32 s64, 0x7fff, s64
    s_cbranch_scc1 L_k4_t
    s_mov_b32 s66, 1
    s_atomic_add s66, s[20:21], s65 glc
    s_branch L_k4_t
L_k4_bias:
    s_waitcnt lgkmcnt(0)
    s_lshl1_add_u32 s52, s66, -7
    s_sext_i32_i16 s53, s62
    s_min_i32 s53, s53, 0
    s_max_i32 s53, s53, -16
    s_mul_i32 s53, s53, 2
    s_cmp_lt_i32 s52, 0
    s_cselect_b32 s53, s53, 0
    s_add_i32 s52, s52, s53
    s_add_i32 s52, s52, 2
    s_ashr_i32 s52, s52, 2
    v_mov_b32 v8, s52
    v_lshlrev_b32 v9, 7, v0
    buffer_store_short v8, v9, s[44:47], 0 offen
    s_branch L_k4_t
L_v2_round:
    s_cmp_eq_u32 s52, 2
    s_cbranch_scc1 L_v2_bias
    s_cmp_eq_u32 s52, 1
    s_cbranch_scc1 L_v2_take
    buffer_load_dword v20, off, s[32:35], 0 sc1
    s_branch L_v2_t
L_v2_take:
    v_readfirstlane_b32 s52, v20
    s_cmp_eq_u32 s52, 0
    s_cselect_b32 s64, 0x7fff, s64
    s_cbranch_scc1 L_v2_t
    s_mov_b32 s66, 1
    s_atomic_add s66, s[20:21], s65 glc
    s_branch L_v2_t
L_v2_bias:
    s_waitcnt lgkmcnt(0)
    s_lshl1_add_u32 s52, s66, -7
    s_mul_i32 s52, s52, 2
    s_sext_i32_i16 s53, s62
    s_min_i32 s53, s53, 0
    s_max_i32 s53, s53, -16
    s_mul_i32 s53, s53, 3
    s_cmp_lt_i32 s52, 0
    s_cselect_b32 s53, s53, 0
    s_add_i32 s52, s52, s53
    s_add_i32 s52, s52, 2
    s_ashr_i32 s52, s52, 2
    v_mov_b32 v8, s52
    v_lshlrev_b32 v9, 7, v0
    buffer_store_short v8, v9, s[44:47], 0 offen
    s_branch L_v2_t
L_v0_round:
    s_cmp_eq_u32 s52, 2
    s_cbranch_scc1 L_v0_bias
    s_cmp_eq_u32 s52, 1
    s_cbranch_scc1 L_v0_take
    buffer_load_dword v20, off, s[32:35], 0 sc1
    s_branch L_v0_t
L_v0_take:
    v_readfirstlane_b32 s52, v20
    s_cmp_eq_u32 s52, 0
    s_cselect_b32 s64, 0x7fff, s64
    s_cbranch_scc1 L_v0_t
    s_mov_b32 s66, 1
    s_atomic_add s66, s[20:21], s65 glc
    s_branch L_v0_t
L_v0_bias:
    s_waitcnt lgkmcnt(0)
    s_lshl1_add_u32 s52, s66, -7
    s_mul_i32 s52, s52, 2
    s_sext_i32_i16 s53, s62
    s_min_i32 s53, s53, 0
    s_max_i32 s53, s53, -16
    s_mul_i32 s53, s53, 3
    s_cmp_lt_i32 s52, 0
    s_cselect_b32 s53, s53, 0
    s_add_i32 s52, s52, s53
    s_add_i32 s52, s52, 2
    s_ashr_i32 s52, s52, 2
    v_mov_b32 v8, s52
    v_lshlrev_b32 v9, 7, v0
    buffer_store_short v8, v9, s[44:47], 0 offen
    s_branch L_v0_t
L_v1_round:
    s_cmp_eq_u32 s52, 2
    s_cbranch_scc1 L_v1_bias
    s_cmp_eq_u32 s52, 1
    s_cbranch_scc1 L_v1_take
    buffer_load_dword v20, off, s[32:35], 0 sc1
    s_branch L_v1_t
L_v1_take:
    v_readfirstlane_b32 s52, v20
    s_cmp_eq_u32 s52, 0
    s_cselect_b32 s64, 0x7fff, s64
    s_cbranch_scc1 L_v1_t
    s_mov_b32 s66, 1
    s_atomic_add s66, s[20:21], s65 glc
    s_branch L_v1_t
L_v1_bias:
    s_waitcnt lgkmcnt(0)
    s_lshl1_add_u32 s52, s66, -7
    s_mul_i32 s52, s52, 2
    s_sext_i32_i16 s53, s62
    s_min_i32 s53, s53, 0
    s_max_i32 s53, s53, -16
    s_mul_i32 s53, s53, 3
    s_cmp_lt_i32 s52, 0
    s_cselect_b32 s53, s53, 0
    s_add_i32 s52, s52, s53
    s_add_i32 s52, s52, 2
    s_ashr_i32 s52, s52, 2
    v_mov_b32 v8, s52
    v_lshlrev_b32 v9, 7, v0
    buffer_store_short v8, v9, s[44:47], 0 offen
    s_branch L_v1_t
L_v3_round:
    s_cmp_eq_u32 s52, 2
    s_cbranch_scc1 L_v3_bias
    s_cmp_eq_u32 s52, 1
    s_cbranch_scc1 L_v3_take
    buffer_load_dword v20, off, s[32:35], 0 sc1
    s_branch L_v3_t
L_v3_take:
    v_readfirstlane_b32 s52, v20
    s_cmp_eq_u32 s52, 0
    s_cselect_b32 s64, 0x7fff, s64
    s_cbranch_scc1 L_v3_t
    s_mov_b32 s66, 1
    s_atomic_add s66, s[20:21], s65 glc
    s_branch L_v3_t
L_v3_bias:
    s_waitcnt lgkmcnt(0)
    s_lshl1_add_u32 s52, s66, -7
    s_mul_i32 s52, s52, 2
    s_sext_i32_i16 s53, s62
    s_min_i32 s53, s53, 0
    s_max_i32 s53, s53, -16
    s_mul_i32 s53, s53, 3
    s_cmp_lt_i32 s52, 0
    s_cselect_b32 s53, s53, 0
    s_add_i32 s52, s52, s53
    s_add_i32 s52, s52, 2
    s_ashr_i32 s52, s52, 2
    v_mov_b32 v8, s52
    v_lshlrev_b32 v9, 7, v0
    buffer_store_short v8, v9, s[44:47], 0 offen
    s_branch L_v3_t
L_v4_round:
    s_cmp_eq_u32 s52, 2
    s_cbranch_scc1 L_v4_bias
    s_cmp_eq_u32 s52, 1
    s_cbranch_scc1 L_v4_take
    buffer_load_dword v20, off, s[32:35], 0 sc1
    s_branch L_v4_t
L_v4_take:
    v_readfirstlane_b32 s52, v20
    s_cmp_eq_u32 s52, 0
    s_cselect_b32 s64, 0x7fff, s64
    s_cbranch_scc1 L_v4_t
    s_mov_b32 s66, 1
    s_atomic_add s66, s[20:21], s65 glc
    s_branch L_v4_t
L_v4_bias:
    s_waitcnt lgkmcnt(0)
    s_lshl1_add_u32 s52, s66, -7
    s_mul_i32 s52, s52, 2
    s_sext_i32_i16 s53, s62
    s_min_i32 s53, s53, 0
    s_max_i32 s53, s53, -16
    s_mul_i32 s53, s53, 3
    s_cmp_lt_i32 s52, 0
    s_cselect_b32 s53, s53, 0
    s_add_i32 s52, s52, s53
    s_add_i32 s52, s52, 2
    s_ashr_i32 s52, s52, 2
    v_mov_b32 v8, s52
    v_lshlrev_b32 v9, 7, v0
    buffer_store_short v8, v9, s[44:47], 0 offen
    s_branch L_v4_t
L_code_end:
.section .rodata,"a"
.p2align 6
.amdhsa_kernel standalone__tree_speculative_verify_tree_attention_over_candidate_token_tree__decode_kernel
  .amdhsa_next_free_vgpr 196
  .amdhsa_next_free_sgpr 78
  .amdhsa_accum_offset 196
  .amdhsa_group_segment_fixed_size 0
  .amdhsa_kernarg_size 72
  .amdhsa_user_sgpr_count 2
  .amdhsa_user_sgpr_kernarg_segment_ptr 1
  .amdhsa_system_sgpr_workgroup_id_x 1
  .amdhsa_float_denorm_mode_32 3
.end_amdhsa_kernel
```
